```python
import torch

def _softmax(x, axis=-1):
    return torch.softmax(x, dim=axis)
def _gelu(x):
    return torch.nn.functional.gelu(x, approximate="tanh")
def _silu(x):
    return torch.nn.functional.silu(x)
def _sigmoid(x):
    return torch.sigmoid(x)
def _layernorm(x, axis=-1, eps=1e-5):
    m = x.mean(dim=axis, keepdim=True)
    v = x.var(dim=axis, keepdim=True, unbiased=False)
    return (x - m) / torch.sqrt(v + eps)
def _scatter_add(tgt, idx, src, axis=0):
    return tgt.clone().index_add_(axis, idx, src)
def _segment_sum(src, seg, n):
    out = torch.zeros((n,) + src.shape[1:], dtype=src.dtype)
    return out.index_add_(0, seg, src)
def _pad(x, pw):
    flat = tuple(v for pair in reversed(pw) for v in pair)
    return torch.nn.functional.pad(x, flat)

kernel_name = 'gated_mix__ssm_conv_s4d__moe_arch_mod__prompt'

def setup_inputs():

    _w = (lambda a: (lambda t: t.to(torch.bfloat16) if t.is_floating_point() else t)(torch.as_tensor(a)))
    def _A_setup():
        Bsz, L, D, N = 1, 2048, 512, 128
        return {
            "u": _w((lambda *s: torch.randn(*s, dtype=torch.bfloat16) * 0.05)(Bsz, L, D)),
            "log_A_real": _w((lambda *s: torch.randn(*s, dtype=torch.bfloat16) * 3.2)(D, N) * 0.5),
            "A_imag": _w((lambda *s: torch.randn(*s, dtype=torch.bfloat16) * 0.1)(D, N) * 3.14),
            "C_real": _w((lambda *s: torch.randn(*s, dtype=torch.bfloat16) * 1.6)(D, N) / N ** 0.5),
            "C_imag": _w((lambda *s: torch.randn(*s, dtype=torch.bfloat16) * 1.6)(D, N) / N ** 0.5),
            "log_dt": _w((lambda *s: torch.randn(*s, dtype=torch.bfloat16) * 0.1)(D) * 0.5 - 4.0),
            "D_skip": _w((lambda *s: torch.randn(*s, dtype=torch.bfloat16) * 0.2)(D)),
        }
    _A_in = _A_setup()

    def _B_setup():
        B, S, D, F, C = 1, 2048, 512, 1792, 1
        return {
            "x": _w((lambda *s: torch.randn(*s, dtype=torch.bfloat16) * 0.05)(B, S, D)),
            "w_r": _w((lambda *s: torch.randn(*s, dtype=torch.bfloat16) * 3.2)(D)),
            "w_gate": _w((lambda *s: torch.randn(*s, dtype=torch.bfloat16) * 0.2)(D, F)),
            "w_up": _w((lambda *s: torch.randn(*s, dtype=torch.bfloat16) * 0.2)(D, F)),
            "w_down": _w((lambda *s: torch.randn(*s, dtype=torch.bfloat16) * 0.2)(F, D)),
        }
    _B_in = _B_setup()

    return {
        "A_u": _A_in["u"],
        "A_log_A_real": _A_in["log_A_real"],
        "A_A_imag": _A_in["A_imag"],
        "A_C_real": _A_in["C_real"],
        "A_C_imag": _A_in["C_imag"],
        "A_log_dt": _A_in["log_dt"],
        "A_D_skip": _A_in["D_skip"],
        "B_x": _B_in["x"],
        "B_w_r": _B_in["w_r"],
        "B_w_gate": _B_in["w_gate"],
        "B_w_up": _B_in["w_up"],
        "B_w_down": _B_in["w_down"],
        "gate_w": _w((lambda *s: torch.randn(*s, dtype=torch.bfloat16) * 0.05)(512) * 16.0),
    }

def reference(A_u, A_log_A_real, A_A_imag, A_C_real, A_C_imag, A_log_dt, A_D_skip, B_x, B_w_r, B_w_gate, B_w_up, B_w_down, gate_w):
    def _A_ref(u, log_A_real, A_imag, C_real, C_imag, log_dt, D_skip):
        L = u.shape[1]
        dt = torch.exp(log_dt)
        A = -torch.exp(log_A_real) + 1j * A_imag
        C = (C_real + 1j * C_imag) * dt[:, None]
        pos = (lambda x, dt: x.to(dt))(torch.arange(L), log_dt.dtype)
        P = torch.exp((A * dt[:, None])[:, :, None] * pos[None, None, :])
        K = 2.0 * torch.einsum("dn,dnl->dl", C, P).real
        L2 = 2 * L
        u_t = (lambda x, *d: x.permute(*d))(u, 0, 2, 1)
        Kf = (lambda x, *a, **k: torch.fft.rfft(x.float(), *a, **k))(K, L2)
        Uf = (lambda x, *a, **k: torch.fft.rfft(x.float(), *a, **k))(u_t, L2)
        y = (lambda x, *a, **k: torch.fft.irfft(x, *a, **k).to(torch.bfloat16))(Uf * Kf[None, :, :], L2)[:, :, :L]
        y = (lambda x, *d: x.permute(*d))(y, 0, 2, 1)
        return y + u * D_skip[None, None, :]

    def _B_ref(x, w_r, w_gate, w_up, w_down):
        B, S, D = x.shape
        C = 1
        r = x @ w_r
        idx = torch.argsort(-r, axis=-1)[:, :C]
        idx_e = (lambda x, n, axis: torch.repeat_interleave(x, n, dim=axis))(idx.reshape(B, C, 1), D, axis=2)
        x_sel = (lambda x, i, axis: torch.take_along_dim(x, i, dim=axis))(x, idx_e, axis=1)
        g = _silu(x_sel @ w_gate)
        u = x_sel @ w_up
        y = (g * u) @ w_down
        r_sel = _sigmoid((lambda x, i, axis: torch.take_along_dim(x, i, dim=axis))(r, idx, axis=1))
        y = y * r_sel.reshape(B, C, 1)
        b_off = (torch.arange(B) * S).reshape(B, 1)
        flat_idx = (idx + b_off).reshape(B * C)
        zero = (x * 0.0).reshape(B * S, D)
        upd = _scatter_add(zero, flat_idx, y.reshape(B * C, D), axis=0)
        return x + upd.reshape(B, S, D)

    x = A_u
    g = _sigmoid((x * gate_w).sum(-1, keepdims=True))
    a = _A_ref(x, A_log_A_real, A_A_imag, A_C_real, A_C_imag, A_log_dt, A_D_skip)
    b = _B_ref(x, B_w_r, B_w_gate, B_w_up, B_w_down)
    return g * a + (1 - g) * b
```

```asm
; @launch grid=(256,1,1) block=(512,1,1) lds=153216
.amdgcn_target "amdgcn-amd-amdhsa--gfx950"
.text
.globl gated_mix__ssm_conv_s4d__moe_arch_mod__prompt_kernel
.p2align 8
.type gated_mix__ssm_conv_s4d__moe_arch_mod__prompt_kernel,@function
gated_mix__ssm_conv_s4d__moe_arch_mod__prompt_kernel:
    s_load_dwordx16 s[8:23], s[0:1], 0
    s_load_dwordx16 s[24:39], s[0:1], 64
    s_cmp_ge_u32 s2, 256
    s_cbranch_scc1 L_end
    v_lshrrev_b32 v1, 6, v0
    v_and_b32 v3, 63, v0
    v_readfirstlane_b32 s40, v1
    s_add_u32 s42, s2, 2
    s_and_b32 s42, s42, 7
    s_lshr_b32 s60, s2, 4
    s_lshl_b32 s41, s42, 4
    s_add_u32 s41, s41, s60
    s_bitcmp1_b32 s2, 3
    s_cbranch_scc0 L_conv
    s_bitcmp1_b32 s2, 4
    s_cbranch_scc1 L_r0
    s_cmp_gt_u32 s40, 1
    s_cbranch_scc1 L_nopf
    s_getpc_b64 s[4:5]
L_pc:
    v_lshlrev_b32 v4, 7, v0
    v_min_u32 v4, L_end-L_pc, v4
    v_mov_b32 v5, 0
    v_lshl_add_u64 v[4:5], v[4:5], 0, s[4:5]
    global_load_dword v2, v[4:5], off
L_nopf:
    s_cmp_lg_u32 s42, 3
    s_cbranch_scc1 L_ffn
    s_lshl_b32 s43, s60, 7
    v_lshrrev_b32 v4, 1, v0
    v_add_u32 v4, s43, v4
    v_lshlrev_b32 v4, 10, v4
    s_waitcnt lgkmcnt(0)
    global_load_dword v4, v4, s[8:9] offset:384
    s_waitcnt vmcnt(0)
    s_branch L_adone
L_r0:
    s_lshr_b32 s41, s41, 1
    v_lshlrev_b32 v4, 4, v3
    s_lshl_b32 s56, s41, 12
    s_lshl_b32 s43, s40, 18
    s_add_u32 s56, s56, s43
    v_add_u32 v5, s56, v4
    s_waitcnt lgkmcnt(0)
    global_load_dwordx4 v[8:11], v4, s[24:25]
    global_load_dwordx4 v[12:15], v4, s[32:33]
    global_load_dwordx4 v[16:19], v5, s[8:9]
    global_load_dwordx4 v[20:23], v5, s[8:9] offset:1024
    global_load_dwordx4 v[24:27], v5, s[8:9] offset:2048
    global_load_dwordx4 v[28:31], v5, s[8:9] offset:3072
    s_load_dword s48, s[38:39], 0
    s_branch L_rg
L_conv:
    s_and_b32 s61, s40, 3
    s_lshr_b32 s63, s40, 2
    s_lshl_b32 s56, s41, 3
    s_lshl_b32 s43, s61, 1
    s_add_u32 s42, s56, s43
    v_mov_b32 v10, s42
    s_add_u32 s42, s42, s63
    s_lshl_b32 s42, s42, 7
    v_lshl_add_u32 v1, v3, 1, s42
    v_mov_b32 v4, 0
    v_mov_b32 v5, 0
    v_mov_b32 v6, 0
    v_mov_b32 v7, 0
    v_mov_b32 v8, 0
    s_waitcnt lgkmcnt(0)
    global_load_short_d16_hi v4, v1, s[10:11]
    global_load_short_d16_hi v8, v10, s[18:19]
    global_load_short_d16_hi v5, v1, s[12:13]
    v_lshlrev_b32 v44, 2, v3
    v_add_u32 v44, 152960, v44
    ds_write_b32 v44, v6
    v_and_b32 v11, 255, v0
    v_lshl_add_u32 v60, v11, 11, s56
    v_add_u32 v61, 524288, v60
    v_add_u32 v62, 1048576, v60
    v_add_u32 v63, 1572864, v60
    s_lshl_b32 s42, s60, 7
    s_lshl_b32 s43, s61, 5
    s_add_u32 s42, s42, s43
    v_and_b32 v13, 31, v3
    v_add_u32 v12, s42, v13
    v_lshl_add_u32 v12, v12, 10, s56
    v_mov_b32 v196, 0
    s_waitcnt lgkmcnt(0)
    s_barrier
    global_load_short_d16_hi v6, v1, s[14:15]
    global_load_short_d16_hi v7, v1, s[16:17]
    s_cmp_ge_u32 s40, 4
    s_cbranch_scc1 L_cio0
    global_load_dword v1, v12, s[8:9]
    s_mov_b64 exec, 1
    global_load_short_d16_hi v196, v10, s[20:21]
    s_mov_b64 exec, -1
    v_mov_b32 v197, 0
    v_mov_b32 v198, 0
    v_mov_b32 v199, 0
    v_mov_b32 v200, 0
    v_mov_b32 v201, 0
    v_mov_b32 v202, 0
    v_mov_b32 v203, 0
    v_mov_b32 v204, 0
    v_mov_b32 v205, 0
    v_mov_b32 v206, 0
    v_mov_b32 v207, 0
    v_mov_b32 v208, 0
    v_mov_b32 v209, 0
    v_mov_b32 v210, 0
    v_mov_b32 v211, 0
    s_mov_b32 s42, 4027516928
    v_bfe_u32 v14, s42, v13, 1
    s_mov_b32 s42, 260061168
    v_bfe_u32 v12, s42, v13, 1
    v_lshl_or_b32 v14, v14, 1, v12
    s_mov_b32 s42, 4034447168
    v_bfe_u32 v12, s42, v13, 1
    v_lshl_or_b32 v14, v14, 1, v12
    s_mov_b32 s42, 6698684
    v_bfe_u32 v12, s42, v13, 1
    v_lshl_or_b32 v14, v14, 1, v12
    s_mov_b32 s42, 4283794746
    v_bfe_u32 v12, s42, v13, 1
    v_lshl_or_b32 v14, v14, 1, v12
    v_lshrrev_b32 v12, 5, v3
    s_mul_i32 s42, s40, 11616
    s_add_u32 s42, s42, 67584
    s_mul_i32 s43, s40, 16896
    v_lshl_add_u32 v10, v12, 4, s42
    v_lshl_add_u32 v11, v12, 4, s43
    s_mov_b32 s56, 528
    v_mad_u32_u24 v14, v14, s56, v10
    v_mad_u32_u24 v15, v13, s56, v11
    s_lshl_b32 s42, s40, 12
    s_add_u32 s42, s42, 132480
    s_add_u32 s56, s42, 1072
    v_lshlrev_b32 v10, 4, v3
    v_sub_u32 v248, s56, v10
    v_and_b32 v10, 1, v3
    v_lshrrev_b32 v11, 1, v3
    v_lshlrev_b32 v11, 2, v11
    s_add_u32 s56, s42, 2528
    v_sub_u32 v11, s56, v11
    v_lshl_add_u32 v249, v10, 8, v11
    v_lshlrev_b32 v250, 7, v10
    v_sub_u32 v250, v11, v250
    v_add_u32 v250, 576, v250
    v_and_b32 v11, 15, v3
    v_and_b32 v12, 48, v3
    v_mul_u32_u24 v13, 1218, v10
    v_lshl_add_u32 v13, v11, 1, v13
    v_sub_u32 v251, v12, v13
    s_add_u32 s56, s42, 1248
    v_add_u32 v251, s56, v251
    v_add_u32 v252, 512, v251
    s_mul_i32 s56, s40, 4608
    s_add_u32 s56, s56, 114048
    v_lshl_add_u32 v253, v11, 5, v12
    v_add_u32 v253, s56, v253
    v_lshl_add_u32 v254, v11, 4, s43
    v_mad_u32_u24 v254, v12, 20, v254
    s_add_u32 s56, s42, 2400
    v_mul_u32_u24 v255, 900, v10
    v_add3_u32 v255, v255, v12, s56
    v_lshlrev_b32 v13, 2, v11
    v_sub_u32 v255, v255, v13
    v_lshrrev_b32 v13, 1, v12
    s_mov_b32 s43, 12288
    v_lshlrev_b32 v244, v11, s43
    v_bfe_u32 v244, v244, v13, 8
    v_lshl_or_b32 v244, v244, 15, v244
    v_lshrrev_b32 v245, 2, v244
    v_lshrrev_b32 v246, 4, v244
    v_lshrrev_b32 v247, 6, v244
    s_mov_b32 s43, 0x10001
    v_and_b32 v244, s43, v244
    v_and_b32 v245, s43, v245
    v_and_b32 v246, s43, v246
    v_and_b32 v247, s43, v247
    s_lshl_b32 s43, s63, 8
    s_mul_i32 s56, s61, 16896
    s_add_u32 m0, s56, s43
    s_mul_i32 s56, s61, 11616
    s_add_u32 s43, s43, s56
    s_add_u32 s43, s43, 16384
    s_cmp_eq_u32 s63, 0
    s_waitcnt vmcnt(4)
    s_branch L_ckgen
L_cio0:
    v_mov_b32 v32, 0
    v_mov_b32 v33, 0
    v_mov_b32 v34, 0
    v_mov_b32 v35, 0
    s_mul_i32 s42, s61, 4608
    s_add_u32 s42, s42, 114048
    v_min_u32 v13, 29, v3
    v_lshl_add_u32 v12, v13, 4, s42
    ds_write_b128 v12, v[32:35]
    s_lshl_b32 s42, s61, 12
    s_add_u32 s42, s42, 132480
    v_lshl_add_u32 v12, v3, 4, s42
    ds_write_b128 v12, v[32:35]
    ds_write_b128 v12, v[32:35] offset:1024
    ds_write_b128 v12, v[32:35] offset:2048
    ds_write_b128 v12, v[32:35] offset:3072
    v_lshlrev_b32 v64, 2, v11
    v_add_u32 v64, 114528, v64
    s_mov_b32 s45, 0x05040100
    s_mov_b32 s46, 0x07060302
    s_mov_b32 s43, 14336
    s_cmp_eq_u32 s61, 1
    s_cselect_b32 s43, 1984, s43
    s_cmp_eq_u32 s61, 2
    s_cselect_b32 s43, 4064, s43
    s_cmp_eq_u32 s61, 3
    s_cselect_b32 s43, 8176, s43
    s_mov_b32 s42, 0x10001
    s_mov_b32 s57, 0x3f80
    s_lshl_b32 s56, s61, 10
    s_add_u32 s56, s56, 148864
    v_lshl_add_u32 v9, v3, 4, s56
    v_and_b32 v10, 15, v3
    v_lshrrev_b32 v13, 4, v3
    v_lshlrev_b32 v13, 3, v13
    v_lshlrev_b32 v12, v10, s43
    v_bfe_u32 v12, v12, v13, 8
    v_lshl_or_b32 v12, v12, 15, v12
    v_lshrrev_b32 v41, 2, v12
    v_lshrrev_b32 v42, 4, v12
    v_lshrrev_b32 v43, 6, v12
    v_and_b32 v40, s42, v12
    v_and_b32 v41, s42, v41
    v_and_b32 v42, s42, v42
    v_and_b32 v43, s42, v43
    v_mul_u32_u24 v40, s57, v40
    v_mul_u32_u24 v41, s57, v41
    v_mul_u32_u24 v42, s57, v42
    v_mul_u32_u24 v43, s57, v43
    ds_write_b128 v9, v[40:43]
    s_setprio 1
    s_lshl_b32 s43, s63, 8
    s_mul_i32 s56, s61, 16896
    s_add_u32 m0, s56, s43
    s_mul_i32 s56, s61, 11616
    s_add_u32 s43, s43, s56
    s_add_u32 s43, s43, 16384
    s_cmp_eq_u32 s63, 0
    s_waitcnt vmcnt(2)
L_ckgen:
    v_mul_f32 v10, 0x3fb8aa3b, v4
    v_mul_f32 v11, 0x3fb8aa3b, v8
    v_exp_f32 v10, v10
    v_exp_f32 v11, v11
    v_mov_b32 v35, 0x3f80
    v_cvt_pk_bf16_f32 v10, v10, v11
    ds_write_addtid_b32 v35 offset:0
    v_and_b32 v8, 0xffff0000, v10
    v_lshlrev_b32 v10, 16, v10
    v_mul_f32 v5, v5, v8
    v_mul_f32 v4, v10, v8
    v_mul_f32 v11, 0x3fa2f983, v5
    v_mul_f32 v10, 0xc138aa3b, v4
    v_fract_f32 v11, v11
    v_exp_f32 v10, v10
    v_cos_f32 v38, v11
    v_sin_f32 v39, v11
    v_mul_f32 v13, 0x3e22f983, v5
    v_pk_mul_f32 v[38:39], v[38:39], v[10:11] op_sel:[0,0] op_sel_hi:[1,0]
    v_cvt_pk_bf16_f32 v32, v38, v39
    v_pk_mul_f32 v[46:47], v[38:39], v[38:39] op_sel:[0,0] op_sel_hi:[0,1]
    ds_write_addtid_b32 v32 offset:528
    v_pk_fma_f32 v[46:47], v[38:39], v[38:39], v[46:47] op_sel:[1,1,0] op_sel_hi:[1,0,1] neg_lo:[1,0,0]
    v_cvt_pk_bf16_f32 v33, v46, v47
    v_mul_f32 v12, 0xbfb8aa3b, v4
    v_pk_mul_f32 v[48:49], v[46:47], v[38:39] op_sel:[0,0] op_sel_hi:[0,1]
    ds_write_addtid_b32 v33 offset:1056
    v_pk_fma_f32 v[48:49], v[46:47], v[38:39], v[48:49] op_sel:[1,1,0] op_sel_hi:[1,0,1] neg_lo:[1,0,0]
    v_cvt_pk_bf16_f32 v34, v48, v49
    v_fract_f32 v13, v13
    v_pk_mul_f32 v[46:47], v[48:49], v[38:39] op_sel:[0,0] op_sel_hi:[0,1]
    ds_write_addtid_b32 v34 offset:1584
    v_pk_fma_f32 v[46:47], v[48:49], v[38:39], v[46:47] op_sel:[1,1,0] op_sel_hi:[1,0,1] neg_lo:[1,0,0]
    v_cvt_pk_bf16_f32 v35, v46, v47
    v_exp_f32 v12, v12
    v_pk_mul_f32 v[48:49], v[46:47], v[38:39] op_sel:[0,0] op_sel_hi:[0,1]
    ds_write_addtid_b32 v35 offset:2112
    v_pk_fma_f32 v[48:49], v[46:47], v[38:39], v[48:49] op_sel:[1,1,0] op_sel_hi:[1,0,1] neg_lo:[1,0,0]
    v_cvt_pk_bf16_f32 v32, v48, v49
    v_cos_f32 v36, v13
    v_pk_mul_f32 v[46:47], v[48:49], v[38:39] op_sel:[0,0] op_sel_hi:[0,1]
    ds_write_addtid_b32 v32 offset:2640
    v_pk_fma_f32 v[46:47], v[48:49], v[38:39], v[46:47] op_sel:[1,1,0] op_sel_hi:[1,0,1] neg_lo:[1,0,0]
    v_cvt_pk_bf16_f32 v33, v46, v47
    v_sin_f32 v37, v13
    v_pk_mul_f32 v[48:49], v[46:47], v[38:39] op_sel:[0,0] op_sel_hi:[0,1]
    ds_write_addtid_b32 v33 offset:3168
    v_pk_fma_f32 v[48:49], v[46:47], v[38:39], v[48:49] op_sel:[1,1,0] op_sel_hi:[1,0,1] neg_lo:[1,0,0]
    v_cvt_pk_bf16_f32 v34, v48, v49
    v_add_f32 v8, v8, v8
    v_pk_mul_f32 v[46:47], v[48:49], v[38:39] op_sel:[0,0] op_sel_hi:[0,1]
    ds_write_addtid_b32 v34 offset:3696
    v_pk_fma_f32 v[46:47], v[48:49], v[38:39], v[46:47] op_sel:[1,1,0] op_sel_hi:[1,0,1] neg_lo:[1,0,0]
    v_cvt_pk_bf16_f32 v35, v46, v47
    v_pk_mul_f32 v[36:37], v[36:37], v[12:13] op_sel:[0,0] op_sel_hi:[1,0]
    s_cbranch_scc1 L_mid0
    global_load_dwordx2 v[16:17], v60, s[8:9]
    global_load_dwordx2 v[18:19], v60, s[8:9] offset:1024
L_mid0:
    v_pk_mul_f32 v[48:49], v[46:47], v[38:39] op_sel:[0,0] op_sel_hi:[0,1]
    ds_write_addtid_b32 v35 offset:4224
    v_pk_fma_f32 v[48:49], v[46:47], v[38:39], v[48:49] op_sel:[1,1,0] op_sel_hi:[1,0,1] neg_lo:[1,0,0]
    v_cvt_pk_bf16_f32 v32, v48, v49
    v_pk_mul_f32 v[46:47], v[48:49], v[38:39] op_sel:[0,0] op_sel_hi:[0,1]
    ds_write_addtid_b32 v32 offset:4752
    v_pk_fma_f32 v[46:47], v[48:49], v[38:39], v[46:47] op_sel:[1,1,0] op_sel_hi:[1,0,1] neg_lo:[1,0,0]
    v_cvt_pk_bf16_f32 v33, v46, v47
    v_pk_mul_f32 v[48:49], v[46:47], v[38:39] op_sel:[0,0] op_sel_hi:[0,1]
    ds_write_addtid_b32 v33 offset:5280
    v_pk_fma_f32 v[48:49], v[46:47], v[38:39], v[48:49] op_sel:[1,1,0] op_sel_hi:[1,0,1] neg_lo:[1,0,0]
    v_cvt_pk_bf16_f32 v34, v48, v49
    v_pk_mul_f32 v[46:47], v[48:49], v[38:39] op_sel:[0,0] op_sel_hi:[0,1]
    ds_write_addtid_b32 v34 offset:5808
    v_pk_fma_f32 v[46:47], v[48:49], v[38:39], v[46:47] op_sel:[1,1,0] op_sel_hi:[1,0,1] neg_lo:[1,0,0]
    v_cvt_pk_bf16_f32 v35, v46, v47
    v_pk_mul_f32 v[48:49], v[46:47], v[38:39] op_sel:[0,0] op_sel_hi:[0,1]
    ds_write_addtid_b32 v35 offset:6336
    v_pk_fma_f32 v[48:49], v[46:47], v[38:39], v[48:49] op_sel:[1,1,0] op_sel_hi:[1,0,1] neg_lo:[1,0,0]
    v_cvt_pk_bf16_f32 v32, v48, v49
    v_pk_mul_f32 v[46:47], v[48:49], v[38:39] op_sel:[0,0] op_sel_hi:[0,1]
    ds_write_addtid_b32 v32 offset:6864
    v_pk_fma_f32 v[46:47], v[48:49], v[38:39], v[46:47] op_sel:[1,1,0] op_sel_hi:[1,0,1] neg_lo:[1,0,0]
    v_cvt_pk_bf16_f32 v33, v46, v47
    v_pk_mul_f32 v[48:49], v[46:47], v[38:39] op_sel:[0,0] op_sel_hi:[0,1]
    ds_write_addtid_b32 v33 offset:7392
    v_pk_fma_f32 v[48:49], v[46:47], v[38:39], v[48:49] op_sel:[1,1,0] op_sel_hi:[1,0,1] neg_lo:[1,0,0]
    v_cvt_pk_bf16_f32 v34, v48, v49
    v_pk_mul_f32 v[46:47], v[48:49], v[38:39] op_sel:[0,0] op_sel_hi:[0,1]
    ds_write_addtid_b32 v34 offset:7920
    v_pk_fma_f32 v[46:47], v[48:49], v[38:39], v[46:47] op_sel:[1,1,0] op_sel_hi:[1,0,1] neg_lo:[1,0,0]
    v_cvt_pk_bf16_f32 v35, v46, v47
    v_pk_mul_f32 v[48:49], v[46:47], v[38:39] op_sel:[0,0] op_sel_hi:[0,1]
    ds_write_addtid_b32 v35 offset:8448
    v_pk_fma_f32 v[48:49], v[46:47], v[38:39], v[48:49] op_sel:[1,1,0] op_sel_hi:[1,0,1] neg_lo:[1,0,0]
    v_cvt_pk_bf16_f32 v32, v48, v49
    v_pk_mul_f32 v[46:47], v[48:49], v[38:39] op_sel:[0,0] op_sel_hi:[0,1]
    ds_write_addtid_b32 v32 offset:8976
    v_pk_fma_f32 v[46:47], v[48:49], v[38:39], v[46:47] op_sel:[1,1,0] op_sel_hi:[1,0,1] neg_lo:[1,0,0]
    v_cvt_pk_bf16_f32 v33, v46, v47
    v_pk_mul_f32 v[48:49], v[46:47], v[38:39] op_sel:[0,0] op_sel_hi:[0,1]
    ds_write_addtid_b32 v33 offset:9504
    v_pk_fma_f32 v[48:49], v[46:47], v[38:39], v[48:49] op_sel:[1,1,0] op_sel_hi:[1,0,1] neg_lo:[1,0,0]
    v_cvt_pk_bf16_f32 v34, v48, v49
    v_pk_mul_f32 v[46:47], v[48:49], v[38:39] op_sel:[0,0] op_sel_hi:[0,1]
    ds_write_addtid_b32 v34 offset:10032
    v_pk_fma_f32 v[46:47], v[48:49], v[38:39], v[46:47] op_sel:[1,1,0] op_sel_hi:[1,0,1] neg_lo:[1,0,0]
    v_cvt_pk_bf16_f32 v35, v46, v47
    v_pk_mul_f32 v[48:49], v[46:47], v[38:39] op_sel:[0,0] op_sel_hi:[0,1]
    ds_write_addtid_b32 v35 offset:10560
    v_pk_fma_f32 v[48:49], v[46:47], v[38:39], v[48:49] op_sel:[1,1,0] op_sel_hi:[1,0,1] neg_lo:[1,0,0]
    v_cvt_pk_bf16_f32 v32, v48, v49
    v_pk_mul_f32 v[46:47], v[48:49], v[38:39] op_sel:[0,0] op_sel_hi:[0,1]
    ds_write_addtid_b32 v32 offset:11088
    v_pk_fma_f32 v[46:47], v[48:49], v[38:39], v[46:47] op_sel:[1,1,0] op_sel_hi:[1,0,1] neg_lo:[1,0,0]
    v_cvt_pk_bf16_f32 v33, v46, v47
    v_pk_mul_f32 v[48:49], v[46:47], v[38:39] op_sel:[0,0] op_sel_hi:[0,1]
    ds_write_addtid_b32 v33 offset:11616
    v_pk_fma_f32 v[48:49], v[46:47], v[38:39], v[48:49] op_sel:[1,1,0] op_sel_hi:[1,0,1] neg_lo:[1,0,0]
    v_cvt_pk_bf16_f32 v34, v48, v49
    v_pk_mul_f32 v[46:47], v[48:49], v[38:39] op_sel:[0,0] op_sel_hi:[0,1]
    ds_write_addtid_b32 v34 offset:12144
    v_pk_fma_f32 v[46:47], v[48:49], v[38:39], v[46:47] op_sel:[1,1,0] op_sel_hi:[1,0,1] neg_lo:[1,0,0]
    v_cvt_pk_bf16_f32 v35, v46, v47
    v_pk_mul_f32 v[48:49], v[46:47], v[38:39] op_sel:[0,0] op_sel_hi:[0,1]
    ds_write_addtid_b32 v35 offset:12672
    v_pk_fma_f32 v[48:49], v[46:47], v[38:39], v[48:49] op_sel:[1,1,0] op_sel_hi:[1,0,1] neg_lo:[1,0,0]
    v_cvt_pk_bf16_f32 v32, v48, v49
    v_pk_mul_f32 v[46:47], v[48:49], v[38:39] op_sel:[0,0] op_sel_hi:[0,1]
    ds_write_addtid_b32 v32 offset:13200
    v_pk_fma_f32 v[46:47], v[48:49], v[38:39], v[46:47] op_sel:[1,1,0] op_sel_hi:[1,0,1] neg_lo:[1,0,0]
    v_cvt_pk_bf16_f32 v33, v46, v47
    v_pk_mul_f32 v[48:49], v[46:47], v[38:39] op_sel:[0,0] op_sel_hi:[0,1]
    ds_write_addtid_b32 v33 offset:13728
    v_pk_fma_f32 v[48:49], v[46:47], v[38:39], v[48:49] op_sel:[1,1,0] op_sel_hi:[1,0,1] neg_lo:[1,0,0]
    v_cvt_pk_bf16_f32 v34, v48, v49
    v_pk_mul_f32 v[46:47], v[48:49], v[38:39] op_sel:[0,0] op_sel_hi:[0,1]
    ds_write_addtid_b32 v34 offset:14256
    v_pk_fma_f32 v[46:47], v[48:49], v[38:39], v[46:47] op_sel:[1,1,0] op_sel_hi:[1,0,1] neg_lo:[1,0,0]
    v_cvt_pk_bf16_f32 v35, v46, v47
    s_cbranch_scc1 L_mid1
    global_load_dwordx2 v[20:21], v61, s[8:9]
    global_load_dwordx2 v[22:23], v61, s[8:9] offset:1024
L_mid1:
    v_pk_mul_f32 v[48:49], v[46:47], v[38:39] op_sel:[0,0] op_sel_hi:[0,1]
    ds_write_addtid_b32 v35 offset:14784
    v_pk_fma_f32 v[48:49], v[46:47], v[38:39], v[48:49] op_sel:[1,1,0] op_sel_hi:[1,0,1] neg_lo:[1,0,0]
    v_cvt_pk_bf16_f32 v32, v48, v49
    v_pk_mul_f32 v[46:47], v[48:49], v[38:39] op_sel:[0,0] op_sel_hi:[0,1]
    ds_write_addtid_b32 v32 offset:15312
    v_pk_fma_f32 v[46:47], v[48:49], v[38:39], v[46:47] op_sel:[1,1,0] op_sel_hi:[1,0,1] neg_lo:[1,0,0]
    v_cvt_pk_bf16_f32 v33, v46, v47
    s_cbranch_scc0 L_cw1
    s_waitcnt vmcnt(2)
L_cw1:
    s_waitcnt vmcnt(4)
    v_pk_mul_f32 v[6:7], v[6:7], v[8:9] op_sel:[0,0] op_sel_hi:[1,0]
    v_pk_mul_f32 v[48:49], v[46:47], v[38:39] op_sel:[0,0] op_sel_hi:[0,1]
    ds_write_addtid_b32 v33 offset:15840
    v_pk_fma_f32 v[48:49], v[46:47], v[38:39], v[48:49] op_sel:[1,1,0] op_sel_hi:[1,0,1] neg_lo:[1,0,0]
    v_cvt_pk_bf16_f32 v34, v48, v49
    v_pk_mul_f32 v[40:41], v[48:49], v[38:39] op_sel:[0,0] op_sel_hi:[0,1]
    ds_write_addtid_b32 v34 offset:16368
    v_pk_fma_f32 v[40:41], v[48:49], v[38:39], v[40:41] op_sel:[1,1,0] op_sel_hi:[1,0,1] neg_lo:[1,0,0]
    s_mov_b32 m0, s43
    v_cvt_pk_bf16_f32 v35, v6, -v7
    v_pk_mul_f32 v[46:47], v[6:7], v[36:37] op_sel:[0,0] op_sel_hi:[0,1]
    ds_write_addtid_b32 v35 offset:51200
    v_pk_fma_f32 v[46:47], v[6:7], v[36:37], v[46:47] op_sel:[1,1,0] op_sel_hi:[1,0,1] neg_lo:[1,0,0]
    v_cvt_pk_bf16_f32 v32, v46, -v47
    v_pk_mul_f32 v[52:53], v[46:47], v[36:37] op_sel:[0,0] op_sel_hi:[0,1]
    ds_write_addtid_b32 v32 offset:51728
    v_pk_fma_f32 v[52:53], v[46:47], v[36:37], v[52:53] op_sel:[1,1,0] op_sel_hi:[1,0,1] neg_lo:[1,0,0]
    v_cvt_pk_bf16_f32 v33, v52, -v53
    v_pk_mul_f32 v[46:47], v[52:53], v[36:37] op_sel:[0,0] op_sel_hi:[0,1]
    ds_write_addtid_b32 v33 offset:52256
    v_pk_fma_f32 v[46:47], v[52:53], v[36:37], v[46:47] op_sel:[1,1,0] op_sel_hi:[1,0,1] neg_lo:[1,0,0]
    v_cvt_pk_bf16_f32 v34, v46, -v47
    v_pk_mul_f32 v[54:55], v[46:47], v[36:37] op_sel:[0,0] op_sel_hi:[0,1]
    ds_write_addtid_b32 v34 offset:52784
    v_pk_fma_f32 v[54:55], v[46:47], v[36:37], v[54:55] op_sel:[1,1,0] op_sel_hi:[1,0,1] neg_lo:[1,0,0]
    v_cvt_pk_bf16_f32 v35, v54, -v55
    v_pk_mul_f32 v[46:47], v[54:55], v[36:37] op_sel:[0,0] op_sel_hi:[0,1]
    ds_write_addtid_b32 v35 offset:58064
    v_pk_fma_f32 v[46:47], v[54:55], v[36:37], v[46:47] op_sel:[1,1,0] op_sel_hi:[1,0,1] neg_lo:[1,0,0]
    v_cvt_pk_bf16_f32 v32, v46, -v47
    v_pk_mul_f32 v[56:57], v[46:47], v[36:37] op_sel:[0,0] op_sel_hi:[0,1]
    ds_write_addtid_b32 v32 offset:58592
    v_pk_fma_f32 v[56:57], v[46:47], v[36:37], v[56:57] op_sel:[1,1,0] op_sel_hi:[1,0,1] neg_lo:[1,0,0]
    v_cvt_pk_bf16_f32 v33, v56, -v57
    v_pk_mul_f32 v[46:47], v[56:57], v[36:37] op_sel:[0,0] op_sel_hi:[0,1]
    ds_write_addtid_b32 v33 offset:59120
    v_pk_fma_f32 v[46:47], v[56:57], v[36:37], v[46:47] op_sel:[1,1,0] op_sel_hi:[1,0,1] neg_lo:[1,0,0]
    v_cvt_pk_bf16_f32 v34, v46, -v47
    v_pk_mul_f32 v[58:59], v[46:47], v[36:37] op_sel:[0,0] op_sel_hi:[0,1]
    ds_write_addtid_b32 v34 offset:59648
    v_pk_fma_f32 v[58:59], v[46:47], v[36:37], v[58:59] op_sel:[1,1,0] op_sel_hi:[1,0,1] neg_lo:[1,0,0]
    v_cvt_pk_bf16_f32 v35, v58, -v59
    s_setprio 0
    v_pk_mul_f32 v[46:47], v[6:7], v[40:41] op_sel:[0,0] op_sel_hi:[0,1]
    ds_write_addtid_b32 v35 offset:60176
    v_pk_fma_f32 v[46:47], v[6:7], v[40:41], v[46:47] op_sel:[1,1,0] op_sel_hi:[1,0,1] neg_lo:[1,0,0]
    v_cvt_pk_bf16_f32 v32, v46, -v47
    v_pk_mul_f32 v[46:47], v[52:53], v[40:41] op_sel:[0,0] op_sel_hi:[0,1]
    ds_write_addtid_b32 v32 offset:57008
    v_pk_fma_f32 v[46:47], v[52:53], v[40:41], v[46:47] op_sel:[1,1,0] op_sel_hi:[1,0,1] neg_lo:[1,0,0]
    v_cvt_pk_bf16_f32 v33, v46, -v47
    v_pk_mul_f32 v[46:47], v[56:57], v[40:41] op_sel:[0,0] op_sel_hi:[0,1]
    ds_write_addtid_b32 v33 offset:57536
    v_pk_fma_f32 v[46:47], v[56:57], v[40:41], v[46:47] op_sel:[1,1,0] op_sel_hi:[1,0,1] neg_lo:[1,0,0]
    v_cvt_pk_bf16_f32 v34, v46, -v47
    v_pk_mul_f32 v[46:47], v[54:55], v[40:41] op_sel:[0,0] op_sel_hi:[0,1]
    ds_write_addtid_b32 v34 offset:53312
    v_pk_fma_f32 v[46:47], v[54:55], v[40:41], v[46:47] op_sel:[1,1,0] op_sel_hi:[1,0,1] neg_lo:[1,0,0]
    v_cvt_pk_bf16_f32 v35, v46, -v47
    v_pk_mul_f32 v[48:49], v[46:47], v[40:41] op_sel:[0,0] op_sel_hi:[0,1]
    ds_write_addtid_b32 v35 offset:56480
    v_pk_fma_f32 v[48:49], v[46:47], v[40:41], v[48:49] op_sel:[1,1,0] op_sel_hi:[1,0,1] neg_lo:[1,0,0]
    v_cvt_pk_bf16_f32 v32, v48, -v49
    v_pk_mul_f32 v[46:47], v[48:49], v[40:41] op_sel:[0,0] op_sel_hi:[0,1]
    ds_write_addtid_b32 v32 offset:60704
    v_pk_fma_f32 v[46:47], v[48:49], v[40:41], v[46:47] op_sel:[1,1,0] op_sel_hi:[1,0,1] neg_lo:[1,0,0]
    v_cvt_pk_bf16_f32 v33, v46, -v47
    v_pk_mul_f32 v[46:47], v[58:59], v[40:41] op_sel:[0,0] op_sel_hi:[0,1]
    ds_write_addtid_b32 v33 offset:54368
    v_pk_fma_f32 v[46:47], v[58:59], v[40:41], v[46:47] op_sel:[1,1,0] op_sel_hi:[1,0,1] neg_lo:[1,0,0]
    v_cvt_pk_bf16_f32 v34, v46, -v47
    v_pk_mul_f32 v[48:49], v[46:47], v[40:41] op_sel:[0,0] op_sel_hi:[0,1]
    ds_write_addtid_b32 v34 offset:53840
    v_pk_fma_f32 v[48:49], v[46:47], v[40:41], v[48:49] op_sel:[1,1,0] op_sel_hi:[1,0,1] neg_lo:[1,0,0]
    v_cvt_pk_bf16_f32 v35, v48, -v49
    v_pk_mul_f32 v[46:47], v[48:49], v[40:41] op_sel:[0,0] op_sel_hi:[0,1]
    ds_write_addtid_b32 v35 offset:61232
    v_pk_fma_f32 v[46:47], v[48:49], v[40:41], v[46:47] op_sel:[1,1,0] op_sel_hi:[1,0,1] neg_lo:[1,0,0]
    v_cvt_pk_bf16_f32 v32, v46, -v47
    v_pk_mul_f32 v[48:49], v[46:47], v[40:41] op_sel:[0,0] op_sel_hi:[0,1]
    ds_write_addtid_b32 v32 offset:54896
    v_pk_fma_f32 v[48:49], v[46:47], v[40:41], v[48:49] op_sel:[1,1,0] op_sel_hi:[1,0,1] neg_lo:[1,0,0]
    v_cvt_pk_bf16_f32 v33, v48, -v49
    v_pk_mul_f32 v[46:47], v[48:49], v[40:41] op_sel:[0,0] op_sel_hi:[0,1]
    ds_write_addtid_b32 v33 offset:61760
    v_pk_fma_f32 v[46:47], v[48:49], v[40:41], v[46:47] op_sel:[1,1,0] op_sel_hi:[1,0,1] neg_lo:[1,0,0]
    v_cvt_pk_bf16_f32 v34, v46, -v47
    v_pk_mul_f32 v[48:49], v[46:47], v[40:41] op_sel:[0,0] op_sel_hi:[0,1]
    ds_write_addtid_b32 v34 offset:55424
    v_pk_fma_f32 v[48:49], v[46:47], v[40:41], v[48:49] op_sel:[1,1,0] op_sel_hi:[1,0,1] neg_lo:[1,0,0]
    v_cvt_pk_bf16_f32 v35, v48, -v49
    v_pk_mul_f32 v[46:47], v[48:49], v[40:41] op_sel:[0,0] op_sel_hi:[0,1]
    ds_write_addtid_b32 v35 offset:55952
    v_pk_fma_f32 v[46:47], v[48:49], v[40:41], v[46:47] op_sel:[1,1,0] op_sel_hi:[1,0,1] neg_lo:[1,0,0]
    v_cvt_pk_bf16_f32 v32, v46, -v47
    ds_write_addtid_b32 v32 offset:62288
    s_cbranch_scc0 L_cio1
    s_waitcnt vmcnt(0) lgkmcnt(1)
    s_mov_b64 exec, 1
    v_add_f32 v196, -1.0, v196
    s_mov_b64 exec, -1
    ds_read_b128 v[84:87], v14 offset:0
    ds_read_b128 v[88:91], v15 offset:0
    ds_read_b128 v[92:95], v14 offset:32
    ds_read_b128 v[96:99], v15 offset:32
    ds_read_b128 v[100:103], v14 offset:64
    ds_read_b128 v[104:107], v15 offset:64
    s_add_u32 s56, s40, 152960
    v_mov_b32 v9, s56
    v_mov_b32 v8, 152960
    v_mov_b32 v13, -1
    v_and_b32 v12, 1, v3
    s_mov_b32 s56, 4261283334
    v_mul_lo_u32 v12, v12, s56
    v_add_u32 v12, 0x05040100, v12
    v_lshlrev_b32 v10, 4, v3
    v_add_u32 v10, 148864, v10
    s_waitcnt lgkmcnt(4)
    v_mfma_f32_32x32x16_bf16 v[196:211], v[84:87], v[88:91], v[196:211]
    ds_read_b128 v[108:111], v14 offset:96
    ds_read_b128 v[112:115], v15 offset:96
    s_waitcnt lgkmcnt(4)
    v_mfma_f32_32x32x16_bf16 v[196:211], v[92:95], v[96:99], v[196:211]
    ds_read_b128 v[116:119], v14 offset:128
    ds_read_b128 v[120:123], v15 offset:128
    s_waitcnt lgkmcnt(4)
    v_mfma_f32_32x32x16_bf16 v[196:211], v[100:103], v[104:107], v[196:211]
    ds_read_b128 v[124:127], v14 offset:160
    ds_read_b128 v[128:131], v15 offset:160
    s_waitcnt lgkmcnt(4)
    v_mfma_f32_32x32x16_bf16 v[196:211], v[108:111], v[112:115], v[196:211]
    ds_read_u8 v5, v9 offset:96
    ds_read_b128 v[132:135], v14 offset:192
    ds_read_b128 v[136:139], v15 offset:192
    s_waitcnt lgkmcnt(5)
    v_mfma_f32_32x32x16_bf16 v[196:211], v[116:119], v[120:123], v[196:211]
    ds_read_b128 v[140:143], v14 offset:224
    ds_read_b128 v[144:147], v15 offset:224
    s_waitcnt lgkmcnt(5)
    v_mfma_f32_32x32x16_bf16 v[196:211], v[124:127], v[128:131], v[196:211]
    s_waitcnt lgkmcnt(4)
    v_cmp_ne_u32 vcc, 0, v5
    s_cbranch_vccz L_tslow
L_tok:
    ds_read_b128 v[84:87], v14 offset:256
    ds_read_b128 v[88:91], v15 offset:256
    s_waitcnt lgkmcnt(4)
    v_mfma_f32_32x32x16_bf16 v[196:211], v[132:135], v[136:139], v[196:211]
    ds_read_b128 v[92:95], v14 offset:288
    ds_read_b128 v[96:99], v15 offset:288
    s_waitcnt lgkmcnt(4)
    v_mfma_f32_32x32x16_bf16 v[196:211], v[140:143], v[144:147], v[196:211]
    ds_read_b128 v[100:103], v14 offset:320
    ds_read_b128 v[104:107], v15 offset:320
    s_waitcnt lgkmcnt(4)
    v_mfma_f32_32x32x16_bf16 v[196:211], v[84:87], v[88:91], v[196:211]
    ds_read_b128 v[108:111], v14 offset:352
    ds_read_b128 v[112:115], v15 offset:352
    s_waitcnt lgkmcnt(4)
    v_mfma_f32_32x32x16_bf16 v[196:211], v[92:95], v[96:99], v[196:211]
    ds_read_b128 v[116:119], v14 offset:384
    ds_read_b128 v[120:123], v15 offset:384
    s_waitcnt lgkmcnt(4)
    v_mfma_f32_32x32x16_bf16 v[196:211], v[100:103], v[104:107], v[196:211]
    ds_read_b32 v4, v8 offset:32
    ds_read_b128 v[124:127], v14 offset:416
    ds_read_b128 v[128:131], v15 offset:416
    s_waitcnt lgkmcnt(5)
    v_mfma_f32_32x32x16_bf16 v[196:211], v[108:111], v[112:115], v[196:211]
    ds_read_b128 v[132:135], v14 offset:448
    ds_read_b128 v[136:139], v15 offset:448
    s_waitcnt lgkmcnt(5)
    v_mfma_f32_32x32x16_bf16 v[196:211], v[116:119], v[120:123], v[196:211]
    s_waitcnt lgkmcnt(4)
    v_cmp_eq_u32 vcc, -1, v4
    s_cbranch_vccz L_uc0
L_uc0d:
    ds_read_b128 v[140:143], v14 offset:480
    ds_read_b128 v[144:147], v15 offset:480
    ds_read_b128 v[228:231], v10 offset:0
    ds_read_b128 v[232:235], v10 offset:1024
    ds_read_b128 v[240:243], v10 offset:3072
    ds_read_b128 v[236:239], v10 offset:2048
    ds_read_b128 v[148:151], v253 offset:432
    ds_read_b128 v[152:155], v253 offset:448
    s_waitcnt lgkmcnt(10)
    v_mfma_f32_32x32x16_bf16 v[196:211], v[124:127], v[128:131], v[196:211]
    s_waitcnt lgkmcnt(8)
    v_mfma_f32_32x32x16_bf16 v[196:211], v[132:135], v[136:139], v[196:211]
    s_waitcnt lgkmcnt(6)
    v_mfma_f32_32x32x16_bf16 v[196:211], v[140:143], v[144:147], v[196:211]
    ds_read_b128 v[156:159], v253 offset:960
    ds_read_b128 v[160:163], v253 offset:384
    ds_read_b128 v[164:167], v253 offset:896
    s_waitcnt lgkmcnt(4)
    v_mfma_f32_16x16x32_bf16 v[180:183], v[148:151], v[228:231], 0
    ds_read_b128 v[168:171], v253 offset:320
    ds_read_b128 v[124:127], v253 offset:832
    v_mfma_f32_16x16x32_bf16 v[184:187], v[148:151], v[232:235], 0
    ds_read_b128 v[128:131], v253 offset:256
    v_mfma_f32_16x16x32_bf16 v[192:195], v[148:151], v[240:243], 0
    ds_read_b128 v[132:135], v253 offset:768
    s_waitcnt lgkmcnt(7)
    v_mfma_f32_16x16x32_bf16 v[172:175], v[152:155], v[228:231], 0
    ds_read_b128 v[136:139], v253 offset:192
    s_nop 0
    v_cvt_pk_bf16_f32 v84, v203, v202
    v_cvt_pk_bf16_f32 v85, v201, v200
    v_cvt_pk_bf16_f32 v86, v199, v198
    v_cvt_pk_bf16_f32 v87, v197, v196
    ds_write_b128 v248, v[84:87] offset:0
    v_cvt_pk_bf16_f32 v88, v204, v203
    v_cvt_pk_bf16_f32 v89, v202, v201
    v_cvt_pk_bf16_f32 v90, v200, v199
    v_cvt_pk_bf16_f32 v91, v198, v197
    v_cvt_pk_bf16_f32 v94, v196, 0
    ds_write_b128 v248, v[88:91] offset:1216
    s_mov_b64 exec, 1
    ds_write_b32 v248, v94 offset:1232
    s_mov_b64 exec, -1
    ds_read2_b32 v[16:17], v252 offset0:128 offset1:129
    ds_read2_b32 v[18:19], v252 offset0:130 offset1:131
    ds_read2_b32 v[48:49], v252 offset0:0 offset1:1
    ds_read2_b32 v[50:51], v252 offset0:2 offset1:3
    v_mfma_f32_16x16x32_bf16 v[176:179], v[152:155], v[232:235], 0
    v_cvt_pk_bf16_f32 v11, v206, 0
    v_cvt_pk_bf16_f32 v14, 0, v204
    v_cvt_pk_bf16_f32 v15, v204, v204
    v_readlane_b32 s56, v11, 63
    v_mfma_f32_16x16x32_bf16 v[188:191], v[152:155], v[236:239], 0
    v_cvt_pk_bf16_f32 v1, v205, v206
    v_cvt_pk_bf16_f32 v2, v207, v208
    v_subrev_u32 v248, 8, v248
    s_waitcnt lgkmcnt(6)
    ds_read2_b32 v[20:21], v252 offset0:112 offset1:113
    ds_read2_b32 v[22:23], v252 offset0:114 offset1:115
    ds_read2_b32 v[52:53], v251 offset0:112 offset1:113
    ds_read2_b32 v[54:55], v251 offset0:114 offset1:115
    s_waitcnt lgkmcnt(6)
    v_mfma_f32_16x16x32_bf16 v[196:199], v[16:19], v[152:155], 0
    ds_read2_b32 v[24:25], v252 offset0:96 offset1:97
    ds_read2_b32 v[26:27], v252 offset0:98 offset1:99
    v_mfma_f32_16x16x32_bf16 v[200:203], v[16:19], v[156:159], 0
    ds_read2_b32 v[56:57], v251 offset0:96 offset1:97
    ds_read2_b32 v[58:59], v251 offset0:98 offset1:99
    s_waitcnt lgkmcnt(8)
    v_mfma_f32_16x16x32_bf16 v[200:203], v[48:51], v[152:155], v[200:203]
    ds_read2_b32 v[28:29], v252 offset0:80 offset1:81
    v_mfma_f32_16x16x32_bf16 v[204:207], v[48:51], v[156:159], 0
    ds_read2_b32 v[30:31], v252 offset0:82 offset1:83
    s_waitcnt lgkmcnt(8)
    v_mfma_f32_16x16x32_bf16 v[196:199], v[20:23], v[160:163], v[196:199]
    ds_read2_b32 v[60:61], v251 offset0:80 offset1:81
    v_mov_b32_dpp v11, v2 quad_perm:[1,0,3,2] row_mask:0xf bank_mask:0xf
    v_mfma_f32_16x16x32_bf16 v[200:203], v[20:23], v[164:167], v[200:203]
    ds_read2_b32 v[62:63], v251 offset0:82 offset1:83
    v_perm_b32 v2, v11, v2, v12
    s_waitcnt lgkmcnt(8)
    v_mfma_f32_16x16x32_bf16 v[200:203], v[52:55], v[160:163], v[200:203]
    ds_read2_b32 v[32:33], v252 offset0:64 offset1:65
    v_mfma_f32_16x16x32_bf16 v[204:207], v[52:55], v[164:167], v[204:207]
    ds_read2_b32 v[34:35], v252 offset0:66 offset1:67
    v_mul_u32_u24 v244, s56, v244
    s_waitcnt lgkmcnt(8)
    v_mfma_f32_16x16x32_bf16 v[196:199], v[24:27], v[168:171], v[196:199]
    ds_read_b128 v[140:143], v253 offset:704
    v_mul_u32_u24 v245, s56, v245
    v_mfma_f32_16x16x32_bf16 v[200:203], v[24:27], v[124:127], v[200:203]
    ds_read2_b32 v[64:65], v251 offset0:64 offset1:65
    v_mul_u32_u24 v246, s56, v246
    s_waitcnt lgkmcnt(8)
    v_mfma_f32_16x16x32_bf16 v[200:203], v[56:59], v[168:171], v[200:203]
    ds_read2_b32 v[66:67], v251 offset0:66 offset1:67
    v_mul_u32_u24 v247, s56, v247
    v_mfma_f32_16x16x32_bf16 v[204:207], v[56:59], v[124:127], v[204:207]
    ds_read2_b32 v[36:37], v252 offset0:48 offset1:49
    v_cvt_pk_bf16_f32 v180, v180, v184
    s_waitcnt lgkmcnt(8)
    v_mfma_f32_16x16x32_bf16 v[196:199], v[28:31], v[128:131], v[196:199]
    ds_read2_b32 v[38:39], v252 offset0:50 offset1:51
    v_cvt_pk_bf16_f32 v181, v181, v185
    v_mfma_f32_16x16x32_bf16 v[200:203], v[28:31], v[132:135], v[200:203]
    ds_read_b128 v[144:147], v253 offset:128
    v_cvt_pk_bf16_f32 v182, v182, v186
    s_waitcnt lgkmcnt(8)
    v_mfma_f32_16x16x32_bf16 v[200:203], v[60:63], v[128:131], v[200:203]
    ds_read_b128 v[148:151], v253 offset:640
    v_cvt_pk_bf16_f32 v183, v183, v187
    v_mfma_f32_16x16x32_bf16 v[204:207], v[60:63], v[132:135], v[204:207]
    ds_read2_b32 v[68:69], v251 offset0:48 offset1:49
    v_cvt_pk_bf16_f32 v172, v172, v176
    s_waitcnt lgkmcnt(8)
    v_mfma_f32_16x16x32_bf16 v[196:199], v[32:35], v[136:139], v[196:199]
    ds_read_b32 v4, v8 offset:36
    v_cvt_pk_bf16_f32 v173, v173, v177
    s_waitcnt lgkmcnt(8)
    v_mfma_f32_16x16x32_bf16 v[200:203], v[32:35], v[140:143], v[200:203]
    ds_read2_b32 v[70:71], v251 offset0:50 offset1:51
    v_cvt_pk_bf16_f32 v174, v174, v178
    s_waitcnt lgkmcnt(7)
    v_mfma_f32_16x16x32_bf16 v[200:203], v[64:67], v[136:139], v[200:203]
    ds_read2_b32 v[40:41], v252 offset0:32 offset1:33
    ds_read2_b32 v[42:43], v252 offset0:34 offset1:35
    v_cvt_pk_bf16_f32 v175, v175, v179
    v_mfma_f32_16x16x32_bf16 v[204:207], v[64:67], v[140:143], v[204:207]
    ds_read_b128 v[156:159], v253 offset:64
    v_cvt_pk_bf16_f32 v188, v188, v192
    s_waitcnt lgkmcnt(7)
    v_mfma_f32_16x16x32_bf16 v[196:199], v[36:39], v[144:147], v[196:199]
    ds_read_b128 v[160:163], v253 offset:576
    ds_read2_b32 v[72:73], v251 offset0:32 offset1:33
    v_cvt_pk_bf16_f32 v189, v189, v193
    s_waitcnt lgkmcnt(8)
    v_mfma_f32_16x16x32_bf16 v[200:203], v[36:39], v[148:151], v[200:203]
    ds_read2_b32 v[74:75], v251 offset0:34 offset1:35
    v_cvt_pk_bf16_f32 v190, v190, v194
    s_waitcnt lgkmcnt(6)
    v_mfma_f32_16x16x32_bf16 v[200:203], v[68:71], v[144:147], v[200:203]
    ds_read2_b32 v[44:45], v252 offset0:16 offset1:17
    ds_read2_b32 v[46:47], v252 offset0:18 offset1:19
    v_cvt_pk_bf16_f32 v191, v191, v195
    v_mfma_f32_16x16x32_bf16 v[204:207], v[68:71], v[148:151], v[204:207]
    ds_read_b128 v[164:167], v253 offset:0
    ds_read_b128 v[168:171], v253 offset:512
    s_waitcnt lgkmcnt(7)
    v_mfma_f32_16x16x32_bf16 v[196:199], v[40:43], v[156:159], v[196:199]
    ds_read2_b32 v[76:77], v251 offset0:16 offset1:17
    ds_read2_b32 v[78:79], v251 offset0:18 offset1:19
    s_waitcnt lgkmcnt(8)
    v_mfma_f32_16x16x32_bf16 v[200:203], v[40:43], v[160:163], v[200:203]
    s_mov_b32 exec_lo, 0
    s_mov_b32 exec_hi, 0x80000000
    ds_write_b64 v248, v[14:15] offset:0
    s_mov_b64 exec, -1
    s_waitcnt lgkmcnt(7)
    v_mfma_f32_16x16x32_bf16 v[200:203], v[72:75], v[156:159], v[200:203]
    s_mov_b32 exec_lo, 0
    s_mov_b32 exec_hi, 0x80000000
    ds_write_b32 v248, v15 offset:1220
    s_mov_b64 exec, -1
    v_mfma_f32_16x16x32_bf16 v[204:207], v[72:75], v[160:163], v[204:207]
    ds_write2_b32 v249, v1, v1 offset0:0 offset1:225
    s_waitcnt lgkmcnt(6)
    v_mfma_f32_16x16x32_bf16 v[196:199], v[44:47], v[164:167], v[196:199]
    ds_write2_b32 v250, v2, v2 offset0:0 offset1:225
    s_waitcnt lgkmcnt(6)
    v_mfma_f32_16x16x32_bf16 v[200:203], v[44:47], v[168:171], v[200:203]
    ds_read2_b32 v[80:81], v251 offset0:0 offset1:1
    s_waitcnt lgkmcnt(5)
    v_mfma_f32_16x16x32_bf16 v[200:203], v[76:79], v[164:167], v[200:203]
    ds_read2_b32 v[82:83], v251 offset0:2 offset1:3
    v_cmp_eq_u32 vcc, -1, v4
    s_cbranch_vccz L_uc1
L_uc1d:
    ds_read_b128 v[124:127], v253 offset:1472
    s_nop 0
    v_mfma_f32_16x16x32_bf16 v[204:207], v[76:79], v[168:171], v[204:207]
    ds_write_b128 v254, v[196:199] offset:0
    ds_read_b128 v[128:131], v253 offset:1408
    s_waitcnt lgkmcnt(3)
    v_mfma_f32_16x16x32_bf16 v[204:207], v[80:83], v[152:155], v[204:207]
    ds_write_b8 v9, v13 offset:0
    v_mfma_f32_16x16x32_bf16 v[212:215], v[244:247], v[152:155], 0
    ds_read_b128 v[132:135], v253 offset:1344
    ds_read_b128 v[136:139], v253 offset:1280
    s_waitcnt lgkmcnt(5)
    v_mfma_f32_16x16x32_bf16 v[208:211], v[48:51], v[124:127], 0
    ds_write_b128 v254, v[200:203] offset:1280
    v_mfma_f32_16x16x32_bf16 v[204:207], v[16:19], v[124:127], v[204:207]
    ds_write_b8 v9, v13 offset:4
    s_waitcnt lgkmcnt(5)
    v_mfma_f32_16x16x32_bf16 v[208:211], v[52:55], v[128:131], v[208:211]
    ds_read_b128 v[140:143], v253 offset:1216
    v_mfma_f32_16x16x32_bf16 v[204:207], v[20:23], v[128:131], v[204:207]
    ds_read_b128 v[144:147], v253 offset:1152
    s_waitcnt lgkmcnt(5)
    v_mfma_f32_16x16x32_bf16 v[208:211], v[56:59], v[132:135], v[208:211]
    ds_read_b128 v[148:151], v253 offset:1088
    v_mfma_f32_16x16x32_bf16 v[204:207], v[24:27], v[132:135], v[204:207]
    ds_read_b128 v[156:159], v253 offset:1024
    s_waitcnt lgkmcnt(6)
    v_mfma_f32_16x16x32_bf16 v[208:211], v[60:63], v[136:139], v[208:211]
    ds_read_b64 v[96:97], v255 offset:384
    ds_read_b64 v[98:99], v255 offset:392
    v_mfma_f32_16x16x32_bf16 v[204:207], v[28:31], v[136:139], v[204:207]
    ds_read_b64 v[84:85], v255 offset:128
    ds_read_b64 v[86:87], v255 offset:136
    ds_read_b64 v[100:101], v255 offset:320
    s_waitcnt lgkmcnt(8)
    v_mfma_f32_16x16x32_bf16 v[208:211], v[64:67], v[140:143], v[208:211]
    ds_read_b64 v[102:103], v255 offset:328
    ds_read_b64 v[88:89], v255 offset:64
    v_mfma_f32_16x16x32_bf16 v[204:207], v[32:35], v[140:143], v[204:207]
    ds_read_b64 v[90:91], v255 offset:72
    ds_read_b64 v[104:105], v255 offset:256
    s_waitcnt lgkmcnt(11)
    v_mfma_f32_16x16x32_bf16 v[208:211], v[68:71], v[144:147], v[208:211]
    ds_read_b64 v[106:107], v255 offset:264
    ds_read_b64 v[92:93], v255 offset:0
    v_mfma_f32_16x16x32_bf16 v[204:207], v[36:39], v[144:147], v[204:207]
    ds_read_b64 v[94:95], v255 offset:8
    s_waitcnt lgkmcnt(13)
    ds_read_b64 v[108:109], v255 offset:704
    v_mfma_f32_16x16x32_bf16 v[208:211], v[72:75], v[148:151], v[208:211]
    s_waitcnt lgkmcnt(13)
    ds_read_b64 v[110:111], v255 offset:712
    s_waitcnt lgkmcnt(13)
    ds_read_b64 v[112:113], v255 offset:640
    v_mfma_f32_16x16x32_bf16 v[204:207], v[40:43], v[148:151], v[204:207]
    s_waitcnt lgkmcnt(13)
    ds_read_b64 v[114:115], v255 offset:648
    s_waitcnt lgkmcnt(13)
    ds_read_b64 v[116:117], v255 offset:576
    v_mfma_f32_16x16x32_bf16 v[208:211], v[76:79], v[156:159], v[208:211]
    v_mfma_f32_16x16x32_bf16 v[204:207], v[44:47], v[156:159], v[204:207]
    s_waitcnt lgkmcnt(12)
    ds_read_b64 v[118:119], v255 offset:584
    ds_read_b64 v[120:121], v255 offset:512
    v_mfma_f32_16x16x32_bf16 v[204:207], v[180:183], v[96:99], v[204:207]
    s_waitcnt lgkmcnt(12)
    ds_read_b64 v[122:123], v255 offset:520
    ds_read_b128 v[160:163], v253 offset:944
    v_mfma_f32_16x16x32_bf16 v[204:207], v[172:175], v[84:87], v[204:207]
    s_waitcnt lgkmcnt(12)
    ds_read_b128 v[164:167], v253 offset:960
    ds_read_b128 v[168:171], v253 offset:1984
    v_mfma_f32_16x16x32_bf16 v[208:211], v[180:183], v[100:103], v[208:211]
    s_waitcnt lgkmcnt(12)
    ds_read_b128 v[152:155], v253 offset:1920
    s_nop 2
    v_mfma_f32_16x16x32_bf16 v[208:211], v[172:175], v[88:91], v[208:211]
    ds_read_b128 v[124:127], v253 offset:1856
    v_mfma_f32_16x16x32_bf16 v[212:215], v[180:183], v[104:107], v[212:215]
    ds_write_b128 v254, v[204:207] offset:2560
    s_waitcnt lgkmcnt(9)
    v_mfma_f32_16x16x32_bf16 v[212:215], v[172:175], v[92:95], v[212:215]
    ds_write_b8 v9, v13 offset:8
    v_mfma_f32_16x16x32_bf16 v[212:215], v[188:191], v[108:111], v[212:215]
    v_mfma_f32_16x16x32_bf16 v[216:219], v[188:191], v[112:115], 0
    s_waitcnt lgkmcnt(8)
    v_mfma_f32_16x16x32_bf16 v[220:223], v[188:191], v[116:119], 0
    ds_read_b128 v[128:131], v253 offset:1792
    s_waitcnt lgkmcnt(7)
    v_mfma_f32_16x16x32_bf16 v[224:227], v[188:191], v[120:123], 0
    ds_read_b128 v[132:135], v253 offset:1728
    v_mfma_f32_16x16x32_bf16 v[180:183], v[160:163], v[228:231], 0
    ds_read_b128 v[136:139], v253 offset:1664
    v_mfma_f32_16x16x32_bf16 v[184:187], v[160:163], v[232:235], 0
    ds_read_b128 v[140:143], v253 offset:1600
    v_mfma_f32_16x16x32_bf16 v[192:195], v[160:163], v[240:243], 0
    ds_read_b128 v[144:147], v253 offset:1536
    s_waitcnt lgkmcnt(7)
    v_mfma_f32_16x16x32_bf16 v[172:175], v[164:167], v[228:231], 0
    ds_read_b128 v[148:151], v253 offset:1456
    v_mfma_f32_16x16x32_bf16 v[176:179], v[164:167], v[232:235], 0
    ds_read_b128 v[156:159], v253 offset:1472
    v_mfma_f32_16x16x32_bf16 v[188:191], v[164:167], v[236:239], 0
    v_mfma_f32_16x16x32_bf16 v[208:211], v[80:83], v[164:167], v[208:211]
    v_mfma_f32_16x16x32_bf16 v[216:219], v[244:247], v[164:167], v[216:219]
    v_mfma_f32_16x16x32_bf16 v[212:215], v[48:51], v[168:171], v[212:215]
    v_mfma_f32_16x16x32_bf16 v[208:211], v[16:19], v[168:171], v[208:211]
    v_mfma_f32_16x16x32_bf16 v[212:215], v[52:55], v[152:155], v[212:215]
    v_mfma_f32_16x16x32_bf16 v[208:211], v[20:23], v[152:155], v[208:211]
    v_cvt_pk_bf16_f32 v180, v180, v184
    v_mfma_f32_16x16x32_bf16 v[212:215], v[56:59], v[124:127], v[212:215]
    v_cvt_pk_bf16_f32 v181, v181, v185
    v_mfma_f32_16x16x32_bf16 v[208:211], v[24:27], v[124:127], v[208:211]
    v_cvt_pk_bf16_f32 v182, v182, v186
    s_waitcnt lgkmcnt(0)
    v_mfma_f32_16x16x32_bf16 v[212:215], v[60:63], v[128:131], v[212:215]
    v_cvt_pk_bf16_f32 v183, v183, v187
    v_mfma_f32_16x16x32_bf16 v[208:211], v[28:31], v[128:131], v[208:211]
    v_cvt_pk_bf16_f32 v172, v172, v176
    v_mfma_f32_16x16x32_bf16 v[212:215], v[64:67], v[132:135], v[212:215]
    v_cvt_pk_bf16_f32 v173, v173, v177
    v_mfma_f32_16x16x32_bf16 v[208:211], v[32:35], v[132:135], v[208:211]
    v_cvt_pk_bf16_f32 v174, v174, v178
    v_mfma_f32_16x16x32_bf16 v[212:215], v[68:71], v[136:139], v[212:215]
    v_cvt_pk_bf16_f32 v175, v175, v179
    v_mfma_f32_16x16x32_bf16 v[208:211], v[36:39], v[136:139], v[208:211]
    ds_read_b32 v4, v8 offset:40
    v_cvt_pk_bf16_f32 v188, v188, v192
    v_mfma_f32_16x16x32_bf16 v[212:215], v[72:75], v[140:143], v[212:215]
    v_cvt_pk_bf16_f32 v189, v189, v193
    v_mfma_f32_16x16x32_bf16 v[208:211], v[40:43], v[140:143], v[208:211]
    ds_read_b128 v[140:143], v253 offset:1968
    v_cvt_pk_bf16_f32 v190, v190, v194
    v_mfma_f32_16x16x32_bf16 v[212:215], v[76:79], v[144:147], v[212:215]
    v_cvt_pk_bf16_f32 v191, v191, v195
    v_mfma_f32_16x16x32_bf16 v[208:211], v[44:47], v[144:147], v[208:211]
    ds_read_b128 v[144:147], v253 offset:1984
    v_mfma_f32_16x16x32_bf16 v[208:211], v[180:183], v[96:99], v[208:211]
    s_waitcnt lgkmcnt(2)
    v_cmp_eq_u32 vcc, -1, v4
    s_cbranch_vccz L_uc2
L_uc2d:
    ds_read_b128 v[160:163], v253 offset:2496
    v_mfma_f32_16x16x32_bf16 v[208:211], v[172:175], v[84:87], v[208:211]
    ds_read_b128 v[164:167], v253 offset:2432
    ds_read_b128 v[168:171], v253 offset:2368
    v_mfma_f32_16x16x32_bf16 v[212:215], v[180:183], v[100:103], v[212:215]
    ds_read_b128 v[152:155], v253 offset:2304
    s_nop 2
    v_mfma_f32_16x16x32_bf16 v[212:215], v[172:175], v[88:91], v[212:215]
    ds_read_b128 v[124:127], v253 offset:2240
    v_mfma_f32_16x16x32_bf16 v[216:219], v[180:183], v[104:107], v[216:219]
    ds_write_b128 v254, v[208:211] offset:3840
    v_mfma_f32_16x16x32_bf16 v[216:219], v[172:175], v[92:95], v[216:219]
    ds_write_b8 v9, v13 offset:12
    v_mfma_f32_16x16x32_bf16 v[216:219], v[188:191], v[108:111], v[216:219]
    v_mfma_f32_16x16x32_bf16 v[220:223], v[188:191], v[112:115], v[220:223]
    v_mfma_f32_16x16x32_bf16 v[224:227], v[188:191], v[116:119], v[224:227]
    ds_read_b128 v[128:131], v253 offset:2176
    v_mfma_f32_16x16x32_bf16 v[180:183], v[148:151], v[228:231], 0
    ds_read_b128 v[132:135], v253 offset:2112
    v_mfma_f32_16x16x32_bf16 v[184:187], v[148:151], v[232:235], 0
    ds_read_b128 v[136:139], v253 offset:2048
    v_mfma_f32_16x16x32_bf16 v[192:195], v[148:151], v[240:243], 0
    ds_read_b128 v[148:151], v253 offset:3008
    v_mfma_f32_16x16x32_bf16 v[172:175], v[156:159], v[228:231], 0
    v_mfma_f32_16x16x32_bf16 v[176:179], v[156:159], v[232:235], 0
    v_mfma_f32_16x16x32_bf16 v[188:191], v[156:159], v[236:239], 0
    v_mfma_f32_16x16x32_bf16 v[212:215], v[80:83], v[156:159], v[212:215]
    v_mfma_f32_16x16x32_bf16 v[220:223], v[244:247], v[156:159], v[220:223]
    ds_read_b128 v[156:159], v253 offset:2944
    s_waitcnt lgkmcnt(6)
    v_mfma_f32_16x16x32_bf16 v[216:219], v[48:51], v[160:163], v[216:219]
    v_mfma_f32_16x16x32_bf16 v[212:215], v[16:19], v[160:163], v[212:215]
    ds_read_b128 v[160:163], v253 offset:2880
    v_mfma_f32_16x16x32_bf16 v[216:219], v[52:55], v[164:167], v[216:219]
    v_mfma_f32_16x16x32_bf16 v[212:215], v[20:23], v[164:167], v[212:215]
    ds_read_b128 v[164:167], v253 offset:2816
    v_cvt_pk_bf16_f32 v180, v180, v184
    v_mfma_f32_16x16x32_bf16 v[216:219], v[56:59], v[168:171], v[216:219]
    v_cvt_pk_bf16_f32 v181, v181, v185
    v_mfma_f32_16x16x32_bf16 v[212:215], v[24:27], v[168:171], v[212:215]
    ds_read_b128 v[168:171], v253 offset:2752
    v_cvt_pk_bf16_f32 v182, v182, v186
    v_mfma_f32_16x16x32_bf16 v[216:219], v[60:63], v[152:155], v[216:219]
    v_cvt_pk_bf16_f32 v183, v183, v187
    v_mfma_f32_16x16x32_bf16 v[212:215], v[28:31], v[152:155], v[212:215]
    ds_read_b128 v[152:155], v253 offset:2688
    v_cvt_pk_bf16_f32 v172, v172, v176
    v_mfma_f32_16x16x32_bf16 v[216:219], v[64:67], v[124:127], v[216:219]
    v_cvt_pk_bf16_f32 v173, v173, v177
    v_mfma_f32_16x16x32_bf16 v[212:215], v[32:35], v[124:127], v[212:215]
    ds_read_b128 v[124:127], v253 offset:2624
    v_cvt_pk_bf16_f32 v174, v174, v178
    s_waitcnt lgkmcnt(4)
    v_mfma_f32_16x16x32_bf16 v[216:219], v[68:71], v[128:131], v[216:219]
    v_cvt_pk_bf16_f32 v175, v175, v179
    v_mfma_f32_16x16x32_bf16 v[212:215], v[36:39], v[128:131], v[212:215]
    ds_read_b128 v[128:131], v253 offset:2560
    v_cvt_pk_bf16_f32 v188, v188, v192
    v_mfma_f32_16x16x32_bf16 v[216:219], v[72:75], v[132:135], v[216:219]
    v_cvt_pk_bf16_f32 v189, v189, v193
    v_mfma_f32_16x16x32_bf16 v[212:215], v[40:43], v[132:135], v[212:215]
    ds_read_b128 v[132:135], v253 offset:2480
    v_cvt_pk_bf16_f32 v190, v190, v194
    v_mfma_f32_16x16x32_bf16 v[216:219], v[76:79], v[136:139], v[216:219]
    v_cvt_pk_bf16_f32 v191, v191, v195
    v_mfma_f32_16x16x32_bf16 v[212:215], v[44:47], v[136:139], v[212:215]
    ds_read_b128 v[136:139], v253 offset:2496
    v_mfma_f32_16x16x32_bf16 v[212:215], v[180:183], v[96:99], v[212:215]
    v_mfma_f32_16x16x32_bf16 v[212:215], v[172:175], v[84:87], v[212:215]
    v_mfma_f32_16x16x32_bf16 v[216:219], v[180:183], v[100:103], v[216:219]
    s_nop 2
    v_mfma_f32_16x16x32_bf16 v[216:219], v[172:175], v[88:91], v[216:219]
    s_nop 1
    v_mfma_f32_16x16x32_bf16 v[220:223], v[180:183], v[104:107], v[220:223]
    ds_write_b128 v254, v[212:215] offset:5120
    v_mfma_f32_16x16x32_bf16 v[220:223], v[172:175], v[92:95], v[220:223]
    ds_write_b8 v9, v13 offset:16
    v_mfma_f32_16x16x32_bf16 v[220:223], v[188:191], v[108:111], v[220:223]
    v_mfma_f32_16x16x32_bf16 v[224:227], v[188:191], v[112:115], v[224:227]
    v_mfma_f32_16x16x32_bf16 v[180:183], v[140:143], v[228:231], 0
    v_mfma_f32_16x16x32_bf16 v[184:187], v[140:143], v[232:235], 0
    v_mfma_f32_16x16x32_bf16 v[192:195], v[140:143], v[240:243], 0
    v_mfma_f32_16x16x32_bf16 v[172:175], v[144:147], v[228:231], 0
    v_mfma_f32_16x16x32_bf16 v[176:179], v[144:147], v[232:235], 0
    v_mfma_f32_16x16x32_bf16 v[188:191], v[144:147], v[236:239], 0
    v_mfma_f32_16x16x32_bf16 v[216:219], v[80:83], v[144:147], v[216:219]
    v_mfma_f32_16x16x32_bf16 v[224:227], v[244:247], v[144:147], v[224:227]
    v_mfma_f32_16x16x32_bf16 v[220:223], v[48:51], v[148:151], v[220:223]
    v_mfma_f32_16x16x32_bf16 v[216:219], v[16:19], v[148:151], v[216:219]
    v_mfma_f32_16x16x32_bf16 v[220:223], v[52:55], v[156:159], v[220:223]
    v_mfma_f32_16x16x32_bf16 v[216:219], v[20:23], v[156:159], v[216:219]
    v_cvt_pk_bf16_f32 v180, v180, v184
    v_mfma_f32_16x16x32_bf16 v[220:223], v[56:59], v[160:163], v[220:223]
    v_cvt_pk_bf16_f32 v181, v181, v185
    v_mfma_f32_16x16x32_bf16 v[216:219], v[24:27], v[160:163], v[216:219]
    v_cvt_pk_bf16_f32 v182, v182, v186
    s_waitcnt lgkmcnt(0)
    v_mfma_f32_16x16x32_bf16 v[220:223], v[60:63], v[164:167], v[220:223]
    v_cvt_pk_bf16_f32 v183, v183, v187
    v_mfma_f32_16x16x32_bf16 v[216:219], v[28:31], v[164:167], v[216:219]
    v_cvt_pk_bf16_f32 v172, v172, v176
    v_mfma_f32_16x16x32_bf16 v[220:223], v[64:67], v[168:171], v[220:223]
    ds_read_b32 v4, v8 offset:44
    v_cvt_pk_bf16_f32 v173, v173, v177
    v_mfma_f32_16x16x32_bf16 v[216:219], v[32:35], v[168:171], v[216:219]
    v_cvt_pk_bf16_f32 v174, v174, v178
    v_mfma_f32_16x16x32_bf16 v[220:223], v[68:71], v[152:155], v[220:223]
    v_cvt_pk_bf16_f32 v175, v175, v179
    v_mfma_f32_16x16x32_bf16 v[216:219], v[36:39], v[152:155], v[216:219]
    v_cvt_pk_bf16_f32 v188, v188, v192
    v_mfma_f32_16x16x32_bf16 v[220:223], v[72:75], v[124:127], v[220:223]
    v_cvt_pk_bf16_f32 v189, v189, v193
    v_mfma_f32_16x16x32_bf16 v[216:219], v[40:43], v[124:127], v[216:219]
    s_waitcnt lgkmcnt(0)
    v_cmp_eq_u32 vcc, -1, v4
    s_cbranch_vccz L_uc3
L_uc3d:
    ds_read_b128 v[140:143], v253 offset:3520
    v_cvt_pk_bf16_f32 v190, v190, v194
    v_mfma_f32_16x16x32_bf16 v[220:223], v[76:79], v[128:131], v[220:223]
    ds_read_b128 v[144:147], v253 offset:3456
    ds_read_b128 v[148:151], v253 offset:3392
    v_cvt_pk_bf16_f32 v191, v191, v195
    v_mfma_f32_16x16x32_bf16 v[216:219], v[44:47], v[128:131], v[216:219]
    ds_read_b128 v[156:159], v253 offset:3328
    v_mfma_f32_16x16x32_bf16 v[216:219], v[180:183], v[96:99], v[216:219]
    ds_read_b128 v[160:163], v253 offset:3264
    v_mfma_f32_16x16x32_bf16 v[216:219], v[172:175], v[84:87], v[216:219]
    ds_read_b128 v[164:167], v253 offset:3200
    v_mfma_f32_16x16x32_bf16 v[220:223], v[180:183], v[100:103], v[220:223]
    ds_read_b128 v[168:171], v253 offset:3136
    s_nop 2
    v_mfma_f32_16x16x32_bf16 v[220:223], v[172:175], v[88:91], v[220:223]
    ds_read_b128 v[152:155], v253 offset:3072
    v_mfma_f32_16x16x32_bf16 v[224:227], v[180:183], v[104:107], v[224:227]
    ds_write_b128 v254, v[216:219] offset:6400
    v_mfma_f32_16x16x32_bf16 v[224:227], v[172:175], v[92:95], v[224:227]
    ds_write_b8 v9, v13 offset:20
    v_mfma_f32_16x16x32_bf16 v[224:227], v[188:191], v[108:111], v[224:227]
    v_mfma_f32_16x16x32_bf16 v[180:183], v[132:135], v[228:231], 0
    v_mfma_f32_16x16x32_bf16 v[184:187], v[132:135], v[232:235], 0
    ds_read_b128 v[124:127], v253 offset:2992
    v_mfma_f32_16x16x32_bf16 v[172:175], v[136:139], v[228:231], 0
    ds_read_b128 v[128:131], v253 offset:3008
    v_mfma_f32_16x16x32_bf16 v[176:179], v[136:139], v[232:235], 0
    ds_read_b128 v[132:135], v253 offset:4032
    v_mfma_f32_16x16x32_bf16 v[220:223], v[80:83], v[136:139], v[220:223]
    ds_read_b128 v[136:139], v253 offset:3968
    s_waitcnt lgkmcnt(7)
    v_mfma_f32_16x16x32_bf16 v[220:223], v[16:19], v[140:143], v[220:223]
    v_mfma_f32_16x16x32_bf16 v[220:223], v[20:23], v[144:147], v[220:223]
    v_mfma_f32_16x16x32_bf16 v[220:223], v[24:27], v[148:151], v[220:223]
    v_mfma_f32_16x16x32_bf16 v[220:223], v[28:31], v[156:159], v[220:223]
    v_mfma_f32_16x16x32_bf16 v[220:223], v[32:35], v[160:163], v[220:223]
    v_cvt_pk_bf16_f32 v180, v180, v184
    v_cvt_pk_bf16_f32 v181, v181, v185
    v_mfma_f32_16x16x32_bf16 v[220:223], v[36:39], v[164:167], v[220:223]
    v_cvt_pk_bf16_f32 v182, v182, v186
    v_cvt_pk_bf16_f32 v183, v183, v187
    v_mfma_f32_16x16x32_bf16 v[220:223], v[40:43], v[168:171], v[220:223]
    v_cvt_pk_bf16_f32 v172, v172, v176
    v_cvt_pk_bf16_f32 v173, v173, v177
    s_waitcnt lgkmcnt(2)
    v_mfma_f32_16x16x32_bf16 v[220:223], v[44:47], v[152:155], v[220:223]
    v_cvt_pk_bf16_f32 v174, v174, v178
    v_cvt_pk_bf16_f32 v175, v175, v179
    s_nop 0
    v_mfma_f32_16x16x32_bf16 v[220:223], v[180:183], v[96:99], v[220:223]
    v_mfma_f32_16x16x32_bf16 v[220:223], v[172:175], v[84:87], v[220:223]
    v_mfma_f32_16x16x32_bf16 v[224:227], v[48:51], v[140:143], v[224:227]
    ds_read_b128 v[140:143], v253 offset:3904
    s_nop 2
    v_mfma_f32_16x16x32_bf16 v[224:227], v[52:55], v[144:147], v[224:227]
    ds_read_b128 v[144:147], v253 offset:3840
    v_mfma_f32_16x16x32_bf16 v[224:227], v[56:59], v[148:151], v[224:227]
    ds_write_b128 v254, v[220:223] offset:7680
    v_mfma_f32_16x16x32_bf16 v[224:227], v[60:63], v[156:159], v[224:227]
    ds_write_b8 v9, v13 offset:24
    v_mfma_f32_16x16x32_bf16 v[224:227], v[64:67], v[160:163], v[224:227]
    v_mfma_f32_16x16x32_bf16 v[224:227], v[68:71], v[164:167], v[224:227]
    ds_read_b128 v[148:151], v253 offset:3776
    v_mfma_f32_16x16x32_bf16 v[224:227], v[72:75], v[168:171], v[224:227]
    ds_read_b128 v[156:159], v253 offset:3712
    v_mfma_f32_16x16x32_bf16 v[224:227], v[76:79], v[152:155], v[224:227]
    ds_read_b128 v[160:163], v253 offset:3648
    v_mfma_f32_16x16x32_bf16 v[224:227], v[180:183], v[100:103], v[224:227]
    ds_read_b128 v[164:167], v253 offset:3584
    v_mfma_f32_16x16x32_bf16 v[224:227], v[172:175], v[88:91], v[224:227]
    s_cmp_lg_u32 s40, 0
    s_cbranch_scc1 L_nopart0
    s_lshl_b32 s56, s41, 4
    s_add_u32 s56, s56, 32768
    v_min_u32 v10, 55, v3
    v_mul_u32_u24 v10, 2176, v10
    v_add_u32 v10, s56, v10
    global_load_dwordx4 v[108:111], v10, s[38:39] sc1
L_nopart0:
    v_mfma_f32_16x16x32_bf16 v[180:183], v[124:127], v[228:231], 0
    v_mfma_f32_16x16x32_bf16 v[184:187], v[124:127], v[232:235], 0
    v_mfma_f32_16x16x32_bf16 v[172:175], v[128:131], v[228:231], 0
    v_mfma_f32_16x16x32_bf16 v[176:179], v[128:131], v[232:235], 0
    v_mfma_f32_16x16x32_bf16 v[224:227], v[80:83], v[128:131], v[224:227]
    s_waitcnt lgkmcnt(3)
    v_mfma_f32_16x16x32_bf16 v[224:227], v[16:19], v[132:135], v[224:227]
    v_mfma_f32_16x16x32_bf16 v[224:227], v[20:23], v[136:139], v[224:227]
    v_mfma_f32_16x16x32_bf16 v[224:227], v[24:27], v[140:143], v[224:227]
    v_mfma_f32_16x16x32_bf16 v[224:227], v[28:31], v[144:147], v[224:227]
    v_mfma_f32_16x16x32_bf16 v[224:227], v[32:35], v[148:151], v[224:227]
    v_cvt_pk_bf16_f32 v180, v180, v184
    v_cvt_pk_bf16_f32 v181, v181, v185
    s_waitcnt lgkmcnt(0)
    v_mfma_f32_16x16x32_bf16 v[224:227], v[36:39], v[156:159], v[224:227]
    v_cvt_pk_bf16_f32 v182, v182, v186
    v_cvt_pk_bf16_f32 v183, v183, v187
    v_mfma_f32_16x16x32_bf16 v[224:227], v[40:43], v[160:163], v[224:227]
    v_cvt_pk_bf16_f32 v172, v172, v176
    v_cvt_pk_bf16_f32 v173, v173, v177
    v_mfma_f32_16x16x32_bf16 v[224:227], v[44:47], v[164:167], v[224:227]
    v_cvt_pk_bf16_f32 v174, v174, v178
    v_cvt_pk_bf16_f32 v175, v175, v179
    s_nop 0
    v_mfma_f32_16x16x32_bf16 v[224:227], v[180:183], v[96:99], v[224:227]
    v_mfma_f32_16x16x32_bf16 v[224:227], v[172:175], v[84:87], v[224:227]
    s_cmp_lg_u32 s40, 0
    s_cbranch_scc1 L_nopart1
    s_setprio 3
    global_load_dwordx4 v[112:115], v10, s[38:39] sc1
L_nopart1:
    s_nop 5
    ds_write_b128 v254, v[224:227] offset:8960
    ds_write_b8 v9, v13 offset:28
    s_cmp_lg_u32 s40, 0
    s_cbranch_scc1 L_cdone
    s_mov_b32 s51, 1048576
    s_mov_b32 s42, 0x0c0c0400
    s_mov_b32 s43, 0x04000c0c
L_mb:
    ds_read_b128 v[28:31], v8 offset:48
    ds_read_b128 v[20:23], v8 offset:64
    ds_read_b128 v[24:27], v8 offset:80
    ds_read_b32 v4, v8 offset:28
    s_waitcnt lgkmcnt(0)
    v_and_b32 v4, v4, v31
    v_cmp_eq_u32 vcc, -1, v4
    s_cbranch_vccnz L_mbd
    s_sub_u32 s51, s51, 1
    s_cbranch_scc0 L_mb
L_mbd:
    ds_read_b32 v16, v26 offset:0
    ds_read_b32 v17, v26 offset:16896
    ds_read_b32 v18, v26 offset:33792
    ds_read_b32 v19, v26 offset:50688
    v_and_b32 v27, 0x1ffff8, v27
    v_subrev_u32 v5, 56, v3
    v_ashrrev_i32 v5, 31, v5
    v_lshlrev_b32 v5, 8, v5
    s_waitcnt vmcnt(1)
    v_perm_b32 v36, v109, v108, s42
    v_perm_b32 v37, v111, v110, s43
    v_or_b32 v36, v36, v37
    v_cmp_ne_u32 vcc, v28, v36
    s_cbranch_vccz L_ppd
    s_waitcnt vmcnt(0)
    v_mov_b32 v108, v112
    v_mov_b32 v109, v113
    v_mov_b32 v110, v114
    v_mov_b32 v111, v115
    s_mov_b32 s51, 1048576
    s_branch L_pp1
L_pp:
    global_load_dwordx4 v[108:111], v10, s[38:39] sc1
L_pp1:
    s_waitcnt vmcnt(0)
    v_perm_b32 v36, v109, v108, s42
    v_perm_b32 v37, v111, v110, s43
    v_or_b32 v36, v36, v37
    v_cmp_ne_u32 vcc, v28, v36
    s_cbranch_vccz L_ppd
    s_sub_u32 s51, s51, 1
    s_cbranch_scc0 L_pp
L_ppd:
    v_and_b32 v108, v5, v108
    v_and_b32 v110, v5, v110
    v_and_b32 v109, v5, v109
    v_and_b32 v111, v5, v111
    s_waitcnt lgkmcnt(0)
    v_permlane32_swap_b32 v108, v110
    v_permlane32_swap_b32 v109, v111
    v_add_f32 v108, v108, v110
    v_add_f32 v109, v109, v111
    v_fmac_f32 v20, v16, v24
    v_fmac_f32 v21, v17, v24
    v_permlane16_swap_b32 v108, v109
    v_add_f32 v108, v108, v109
    v_fmac_f32 v22, v18, v24
    v_fmac_f32 v23, v19, v24
    v_add_f32_dpp v108, v108, v108 row_ror:8 row_mask:0xf bank_mask:0xf
    s_nop 1
    v_add_f32_dpp v108, v108, v108 row_ror:4 row_mask:0xf bank_mask:0xf
    s_nop 1
    v_add_f32_dpp v108, v108, v108 row_ror:2 row_mask:0xf bank_mask:0xf
    s_nop 1
    v_add_f32_dpp v108, v108, v108 row_ror:1 row_mask:0xf bank_mask:0xf
    v_cvt_pk_bf16_f32 v108, 0, v108
    s_mov_b64 exec, 1
    v_readlane_b32 s43, v108, 16
    v_readlane_b32 s56, v108, 32
    v_readlane_b32 s57, v108, 48
    v_fmac_f32 v20, v108, v25
    v_fmac_f32 v21, s43, v25
    v_fmac_f32 v22, s56, v25
    v_fmac_f32 v23, s57, v25
    v_cvt_pk_bf16_f32 v16, v20, v21
    v_cvt_pk_bf16_f32 v17, v22, v23
    global_store_dwordx2 v27, v[16:17], s[34:35]
    s_branch L_cdone
L_tslow:
    s_mov_b32 s51, 1048576
L_tsl:
    ds_read_u8 v5, v9 offset:96
    s_waitcnt lgkmcnt(0)
    v_cmp_ne_u32 vcc, 0, v5
    s_cbranch_vccnz L_tok
    s_sub_u32 s51, s51, 1
    s_cbranch_scc0 L_tsl
    s_branch L_tok
L_uc0:
    s_mov_b32 s51, 1048576
L_wf_u0:
    ds_read_b32 v4, v8 offset:32
    s_waitcnt lgkmcnt(0)
    v_cmp_eq_u32 vcc, -1, v4
    s_cbranch_vccnz L_wfd_u0
    s_sub_u32 s51, s51, 1
    s_cbranch_scc0 L_wf_u0
L_wfd_u0:
    s_branch L_uc0d
L_uc1:
    s_mov_b32 s51, 1048576
L_wf_u1:
    ds_read_b32 v4, v8 offset:36
    s_waitcnt lgkmcnt(0)
    v_cmp_eq_u32 vcc, -1, v4
    s_cbranch_vccnz L_wfd_u1
    s_sub_u32 s51, s51, 1
    s_cbranch_scc0 L_wf_u1
L_wfd_u1:
    s_branch L_uc1d
L_uc2:
    s_mov_b32 s51, 1048576
L_wf_u2:
    ds_read_b32 v4, v8 offset:40
    s_waitcnt lgkmcnt(0)
    v_cmp_eq_u32 vcc, -1, v4
    s_cbranch_vccnz L_wfd_u2
    s_sub_u32 s51, s51, 1
    s_cbranch_scc0 L_wf_u2
L_wfd_u2:
    s_branch L_uc2d
L_uc3:
    s_mov_b32 s51, 1048576
L_wf_u3:
    ds_read_b32 v4, v8 offset:44
    s_waitcnt lgkmcnt(0)
    v_cmp_eq_u32 vcc, -1, v4
    s_cbranch_vccnz L_wfd_u3
    s_sub_u32 s51, s51, 1
    s_cbranch_scc0 L_wf_u3
L_wfd_u3:
    s_branch L_uc3d
L_cio1:
    s_add_u32 s56, s61, 152992
    v_mov_b32 v68, s56
    v_mov_b32 v59, -1
    ds_write_b8 v68, v59 offset:64
    global_load_dwordx2 v[24:25], v62, s[8:9]
    global_load_dwordx2 v[26:27], v62, s[8:9] offset:1024
    s_waitcnt vmcnt(4)
    v_perm_b32 v40, v18, v16, s45
    v_perm_b32 v41, v18, v16, s46
    v_perm_b32 v42, v19, v17, s45
    v_perm_b32 v43, v19, v17, s46
    ds_write_b32 v64, v40 offset:0
    ds_write_b32 v64, v41 offset:4608
    ds_write_b32 v64, v42 offset:9216
    ds_write_b32 v64, v43 offset:13824
    ds_write_b8 v68, v59
    s_setprio 0
    v_lshlrev_b32 v65, 3, v3
    v_add_u32 v65, 4096, v65
    v_and_b32 v66, 255, v0
    v_lshlrev_b32 v66, 3, v66
    v_add_u32 v66, 12288, v66
    v_mov_b32 v70, 0
    v_bfe_u32 v12, v0, 1, 2
    v_bfe_u32 v13, v0, 7, 1
    v_lshl_add_u32 v12, v13, 2, v12
    v_mul_u32_u24 v67, 320, v12
    v_bfe_u32 v12, v0, 3, 4
    v_lshl_add_u32 v67, v12, 4, v67
    v_and_b32 v12, 1, v0
    v_lshl_add_u32 v67, v12, 3, v67
    v_mov_b32 v69, 152960
    v_lshl_add_u32 v71, v13, 2, v69
    s_waitcnt vmcnt(2)
    v_perm_b32 v40, v22, v20, s45
    v_perm_b32 v41, v22, v20, s46
    v_perm_b32 v42, v23, v21, s45
    v_perm_b32 v43, v23, v21, s46
    ds_write_b32 v64, v40 offset:1024
    ds_write_b32 v64, v41 offset:5632
    ds_write_b32 v64, v42 offset:10240
    ds_write_b32 v64, v43 offset:14848
    ds_write_b8 v68, v59 offset:4
    global_load_dwordx2 v[12:13], v70, s[36:37] sc1
    global_load_dwordx2 v[72:73], v66, s[38:39] offset:-4096 sc1
    global_load_dwordx2 v[28:29], v63, s[8:9]
    global_load_dwordx2 v[30:31], v63, s[8:9] offset:1024
    v_lshlrev_b32 v80, 16, v16
    v_and_b32 v81, 0xffff0000, v16
    v_lshlrev_b32 v82, 16, v17
    v_and_b32 v83, 0xffff0000, v17
    v_lshlrev_b32 v84, 16, v18
    v_and_b32 v85, 0xffff0000, v18
    v_lshlrev_b32 v86, 16, v19
    v_and_b32 v87, 0xffff0000, v19
    v_lshlrev_b32 v88, 16, v20
    v_and_b32 v89, 0xffff0000, v20
    v_lshlrev_b32 v90, 16, v21
    v_and_b32 v91, 0xffff0000, v21
    v_lshlrev_b32 v92, 16, v22
    v_and_b32 v93, 0xffff0000, v22
    v_lshlrev_b32 v94, 16, v23
    v_and_b32 v95, 0xffff0000, v23
    s_waitcnt vmcnt(4)
    v_perm_b32 v40, v26, v24, s45
    v_perm_b32 v41, v26, v24, s46
    v_perm_b32 v42, v27, v25, s45
    v_perm_b32 v43, v27, v25, s46
    ds_write_b32 v64, v40 offset:2048
    ds_write_b32 v64, v41 offset:6656
    ds_write_b32 v64, v42 offset:11264
    ds_write_b32 v64, v43 offset:15872
    ds_write_b8 v68, v59 offset:8
    s_waitcnt vmcnt(2)
    s_setprio 2
    s_mov_b32 s62, 0
    v_cmp_eq_u32 vcc, 1, v13
    v_cmp_eq_u32 s[52:53], v12, v73
    s_and_b64 vcc, vcc, s[52:53]
    s_cmp_eq_u64 vcc, -1
    s_cbranch_scc1 L_pad
    s_waitcnt vmcnt(0)
    v_perm_b32 v40, v30, v28, s45
    v_perm_b32 v41, v30, v28, s46
    v_perm_b32 v42, v31, v29, s45
    v_perm_b32 v43, v31, v29, s46
    ds_write_b32 v64, v40 offset:3072
    ds_write_b32 v64, v41 offset:7680
    ds_write_b32 v64, v42 offset:12288
    ds_write_b32 v64, v43 offset:16896
    ds_write_b8 v68, v59 offset:12
    s_mov_b32 s62, 1
    s_mov_b32 s51, 1048576
L_pa:
    global_load_dwordx2 v[12:13], v70, s[36:37] sc1
    global_load_dwordx2 v[72:73], v66, s[38:39] offset:-4096 sc1
    s_waitcnt vmcnt(0)
    v_cmp_eq_u32 vcc, 1, v13
    v_cmp_eq_u32 s[52:53], v12, v73
    s_and_b64 vcc, vcc, s[52:53]
    s_cmp_eq_u64 vcc, -1
    s_cbranch_scc1 L_pad
    s_sub_u32 s51, s51, 1
    s_cbranch_scc0 L_pa
L_pad:
    global_load_dwordx2 v[52:53], v65, s[38:39] sc1
    global_load_dwordx2 v[74:75], v66, s[38:39] offset:-2048 sc1
    global_load_dwordx2 v[76:77], v66, s[38:39] offset:0 sc1
    global_load_dwordx2 v[78:79], v66, s[38:39] offset:2048 sc1
    v_lshlrev_b32 v112, 16, v72
    v_and_b32 v113, 0xffff0000, v72
    v_readfirstlane_b32 s48, v12
    s_mov_b32 s51, 1048576
L_wf_e0:
    ds_read_b32 v48, v71 offset:0
    s_waitcnt lgkmcnt(0)
    v_cmp_eq_u32 vcc, -1, v48
    s_cbranch_vccnz L_wfd_e0
    s_sub_u32 s51, s51, 1
    s_cbranch_scc0 L_wf_e0
L_wfd_e0:
    ds_read_b64 v[32:33], v67 offset:0
    ds_read_b64 v[34:35], v67 offset:16896
    ds_read_b64 v[36:37], v67 offset:33792
    ds_read_b64 v[38:39], v67 offset:50688
    s_waitcnt lgkmcnt(0)
    v_fmac_f32 v80, v32, v112
    v_fmac_f32 v81, v34, v112
    v_fmac_f32 v82, v36, v112
    v_fmac_f32 v83, v38, v112
    v_cvt_pk_bf16_f32 v80, v80, v81
    v_cvt_pk_bf16_f32 v81, v82, v83
    global_store_dwordx2 v60, v[80:81], s[34:35] offset:0
    v_fmac_f32 v84, v33, v113
    v_fmac_f32 v85, v35, v113
    v_fmac_f32 v86, v37, v113
    v_fmac_f32 v87, v39, v113
    v_cvt_pk_bf16_f32 v84, v84, v85
    v_cvt_pk_bf16_f32 v85, v86, v87
    global_store_dwordx2 v60, v[84:85], s[34:35] offset:1024
    s_cmp_lg_u32 s62, 0
    s_cbranch_scc1 L_s3d
    s_waitcnt vmcnt(6)
    v_perm_b32 v40, v30, v28, s45
    v_perm_b32 v41, v30, v28, s46
    v_perm_b32 v42, v31, v29, s45
    v_perm_b32 v43, v31, v29, s46
    ds_write_b32 v64, v40 offset:3072
    ds_write_b32 v64, v41 offset:7680
    ds_write_b32 v64, v42 offset:12288
    ds_write_b32 v64, v43 offset:16896
    ds_write_b8 v68, v59 offset:12
L_s3d:
    v_lshlrev_b32 v96, 16, v24
    v_and_b32 v97, 0xffff0000, v24
    v_lshlrev_b32 v98, 16, v25
    v_and_b32 v99, 0xffff0000, v25
    v_lshlrev_b32 v100, 16, v26
    v_and_b32 v101, 0xffff0000, v26
    v_lshlrev_b32 v102, 16, v27
    v_and_b32 v103, 0xffff0000, v27
    v_lshlrev_b32 v104, 16, v28
    v_and_b32 v105, 0xffff0000, v28
    v_lshlrev_b32 v106, 16, v29
    v_and_b32 v107, 0xffff0000, v29
    v_lshlrev_b32 v108, 16, v30
    v_and_b32 v109, 0xffff0000, v30
    v_lshlrev_b32 v110, 16, v31
    v_and_b32 v111, 0xffff0000, v31
    s_mov_b32 s51, 1048576
    s_waitcnt vmcnt(2)
    s_branch L_pb1
L_pb:
    global_load_dwordx2 v[52:53], v65, s[38:39] sc1
    global_load_dwordx2 v[74:75], v66, s[38:39] offset:-2048 sc1
    global_load_dwordx2 v[76:77], v66, s[38:39] offset:0 sc1
    global_load_dwordx2 v[78:79], v66, s[38:39] offset:2048 sc1
    s_waitcnt vmcnt(0)
L_pb1:
    v_cmp_eq_u32 vcc, s48, v53
    v_cmp_eq_u32 s[52:53], s48, v75
    v_cmp_eq_u32 s[54:55], s48, v77
    s_and_b64 vcc, vcc, s[52:53]
    v_cmp_eq_u32 s[52:53], s48, v79
    s_and_b64 vcc, vcc, s[54:55]
    s_and_b64 vcc, vcc, s[52:53]
    s_cmp_eq_u64 vcc, -1
    s_cbranch_scc1 L_pbd
    s_sub_u32 s51, s51, 1
    s_cbranch_scc0 L_pb
L_pbd:
    v_max_u32_dpp v52, v52, v52 row_ror:8 row_mask:0xf bank_mask:0xf
    s_nop 1
    v_max_u32_dpp v52, v52, v52 row_ror:4 row_mask:0xf bank_mask:0xf
    s_nop 1
    v_max_u32_dpp v52, v52, v52 row_ror:2 row_mask:0xf bank_mask:0xf
    s_nop 1
    v_max_u32_dpp v52, v52, v52 row_ror:1 row_mask:0xf bank_mask:0xf
    s_nop 1
    v_readlane_b32 s49, v52, 0
    v_readlane_b32 s42, v52, 16
    v_readlane_b32 s43, v52, 32
    v_readlane_b32 s56, v52, 48
    s_max_u32 s49, s49, s42
    s_max_u32 s43, s43, s56
    s_max_u32 s49, s49, s43
    v_lshlrev_b32 v114, 16, v74
    v_and_b32 v115, 0xffff0000, v74
    v_lshlrev_b32 v116, 16, v76
    v_and_b32 v117, 0xffff0000, v76
    v_lshlrev_b32 v118, 16, v78
    v_and_b32 v119, 0xffff0000, v78
    s_andn2_b32 s50, 2047, s49
    s_lshr_b32 s42, s50, 1
    s_mov_b64 s[6:7], -1
    s_bitset0_b64 s[6:7], s42
    s_lshr_b32 s56, s50, 9
    s_lshl_b32 s44, s56, 1
    s_and_b32 s43, s50, 1
    s_add_u32 s44, s44, s43
    s_bfe_u32 s43, s50, 0x20007
    s_cmp_eq_u32 s43, s61
    s_cselect_b32 s44, s44, 8
    s_cbranch_scc0 L_nomb
    s_and_b32 s42, s42, 63
    v_readlane_b32 s43, v72, s42
    v_readlane_b32 s57, v74, s42
    v_readlane_b32 s58, v76, s42
    v_readlane_b32 s59, v78, s42
    s_bitcmp1_b32 s56, 0
    s_cselect_b32 s43, s57, s43
    s_cselect_b32 s58, s59, s58
    s_bitcmp1_b32 s56, 1
    s_cselect_b32 s43, s58, s43
    s_lshl_b32 s57, s44, 1
    s_set_gpr_idx_on s57, 1
    v_mov_b32 v40, v16
    v_mov_b32 v41, v17
    s_set_gpr_idx_off
    s_bitcmp1_b32 s50, 0
    s_cselect_b32 s57, 0, 16
    s_lshl_b32 s43, s43, s57
    s_and_b32 s43, s43, 0xffff0000
    v_readlane_b32 s58, v40, s42
    v_readlane_b32 s59, v41, s42
    s_and_b32 s42, s49, 0xffff0000
    s_xor_b32 s57, s42, 0xffff0000
    s_xor_b32 s42, s42, 0x80000000
    s_bitcmp1_b32 s49, 31
    s_cselect_b32 s42, s42, s57
    v_mov_b32 v45, 0xbfb8aa3b
    v_mul_f32 v45, s42, v45
    v_exp_f32 v45, v45
    v_mov_b32 v44, s43
    v_add_f32 v45, 1.0, v45
    v_rcp_f32 v45, v45
    v_sub_f32 v46, 1.0, v44
    v_cvt_pk_bf16_f32 v45, 0, v45
    v_cvt_pk_bf16_f32 v46, 0, v46
    v_mul_f32 v45, v45, v46
    s_lshl_b32 s42, s58, 16
    s_and_b32 s43, s58, 0xffff0000
    s_lshl_b32 s57, s59, 16
    s_and_b32 s58, s59, 0xffff0000
    v_mov_b32 v40, s42
    v_mov_b32 v41, s43
    v_mov_b32 v42, s57
    v_mov_b32 v43, s58
    s_lshr_b32 s57, s50, 8
    s_lshl_b32 s42, s57, 2
    s_bfe_u32 s43, s50, 0x20002
    s_add_u32 s42, s42, s43
    s_mul_i32 s42, s42, 320
    s_and_b32 s43, s50, 0xf0
    s_add_u32 s42, s42, s43
    s_and_b32 s43, s50, 3
    s_lshl_b32 s43, s43, 2
    s_add_u32 s42, s42, s43
    v_mov_b32 v46, s42
    s_lshl_b32 s42, s50, 10
    s_lshl_b32 s43, s41, 3
    s_add_u32 s42, s42, s43
    v_mov_b32 v47, s42
    ds_write_b128 v69, v[40:43] offset:64
    ds_write_b128 v69, v[44:47] offset:80
    v_mov_b32 v48, s48
    v_mov_b32 v51, -1
    s_cmp_ge_u32 s56, 1
    s_cbranch_scc1 L_mb1
    s_waitcnt vmcnt(0)
L_mb1:
    ds_write_b128 v69, v[48:51] offset:48
L_nomb:
    s_mov_b32 s51, 1048576
L_wf_e1:
    ds_read_b32 v48, v71 offset:8
    s_waitcnt lgkmcnt(0)
    v_cmp_eq_u32 vcc, -1, v48
    s_cbranch_vccnz L_wfd_e1
    s_sub_u32 s51, s51, 1
    s_cbranch_scc0 L_wf_e1
L_wfd_e1:
    ds_read_b64 v[32:33], v67 offset:2560
    ds_read_b64 v[34:35], v67 offset:19456
    ds_read_b64 v[36:37], v67 offset:36352
    ds_read_b64 v[38:39], v67 offset:53248
    s_waitcnt lgkmcnt(0)
    v_fmac_f32 v88, v32, v114
    v_fmac_f32 v89, v34, v114
    v_fmac_f32 v90, v36, v114
    v_fmac_f32 v91, v38, v114
    v_cvt_pk_bf16_f32 v88, v88, v89
    v_cvt_pk_bf16_f32 v89, v90, v91
    s_cmp_eq_u32 s44, 2
    s_cselect_b64 exec, s[6:7], -1
    global_store_dwordx2 v61, v[88:89], s[34:35] offset:0
    s_mov_b64 exec, -1
    v_fmac_f32 v92, v33, v115
    v_fmac_f32 v93, v35, v115
    v_fmac_f32 v94, v37, v115
    v_fmac_f32 v95, v39, v115
    v_cvt_pk_bf16_f32 v92, v92, v93
    v_cvt_pk_bf16_f32 v93, v94, v95
    s_cmp_eq_u32 s44, 3
    s_cselect_b64 exec, s[6:7], -1
    global_store_dwordx2 v61, v[92:93], s[34:35] offset:1024
    s_mov_b64 exec, -1
    s_mov_b32 s51, 1048576
L_wf_e2:
    ds_read_b32 v48, v71 offset:16
    s_waitcnt lgkmcnt(0)
    v_cmp_eq_u32 vcc, -1, v48
    s_cbranch_vccnz L_wfd_e2
    s_sub_u32 s51, s51, 1
    s_cbranch_scc0 L_wf_e2
L_wfd_e2:
    ds_read_b64 v[32:33], v67 offset:5120
    ds_read_b64 v[34:35], v67 offset:22016
    ds_read_b64 v[36:37], v67 offset:38912
    ds_read_b64 v[38:39], v67 offset:55808
    s_waitcnt lgkmcnt(0)
    v_fmac_f32 v96, v32, v116
    v_fmac_f32 v97, v34, v116
    v_fmac_f32 v98, v36, v116
    v_fmac_f32 v99, v38, v116
    v_cvt_pk_bf16_f32 v96, v96, v97
    v_cvt_pk_bf16_f32 v97, v98, v99
    s_cmp_eq_u32 s44, 4
    s_cselect_b64 exec, s[6:7], -1
    global_store_dwordx2 v62, v[96:97], s[34:35] offset:0
    s_mov_b64 exec, -1
    v_fmac_f32 v100, v33, v117
    v_fmac_f32 v101, v35, v117
    v_fmac_f32 v102, v37, v117
    v_fmac_f32 v103, v39, v117
    v_cvt_pk_bf16_f32 v100, v100, v101
    v_cvt_pk_bf16_f32 v101, v102, v103
    s_cmp_eq_u32 s44, 5
    s_cselect_b64 exec, s[6:7], -1
    global_store_dwordx2 v62, v[100:101], s[34:35] offset:1024
    s_mov_b64 exec, -1
    s_mov_b32 s51, 1048576
L_wf_d3:
    ds_read_b32 v48, v71 offset:20
    s_waitcnt lgkmcnt(0)
    v_cmp_eq_u32 vcc, -1, v48
    s_cbranch_vccnz L_wfd_d3
    s_sub_u32 s51, s51, 1
    s_cbranch_scc0 L_wf_d3
L_wfd_d3:
    s_mov_b32 s51, 1048576
L_wf_e3:
    ds_read_b32 v48, v71 offset:24
    ds_read_b64 v[32:33], v67 offset:7680
    ds_read_b64 v[34:35], v67 offset:24576
    ds_read_b64 v[36:37], v67 offset:41472
    ds_read_b64 v[38:39], v67 offset:58368
    s_waitcnt lgkmcnt(4)
    v_cmp_eq_u32 vcc, -1, v48
    s_cbranch_vccnz L_wfd_e3
    s_sub_u32 s51, s51, 1
    s_cbranch_scc0 L_wf_e3
L_wfd_e3:
    s_waitcnt lgkmcnt(0)
    v_fmac_f32 v104, v32, v118
    v_fmac_f32 v105, v34, v118
    v_fmac_f32 v106, v36, v118
    v_fmac_f32 v107, v38, v118
    v_cvt_pk_bf16_f32 v104, v104, v105
    v_cvt_pk_bf16_f32 v105, v106, v107
    s_cmp_eq_u32 s44, 6
    s_cselect_b64 exec, s[6:7], -1
    global_store_dwordx2 v63, v[104:105], s[34:35] offset:0
    s_mov_b64 exec, -1
    v_fmac_f32 v108, v33, v119
    v_fmac_f32 v109, v35, v119
    v_fmac_f32 v110, v37, v119
    v_fmac_f32 v111, v39, v119
    v_cvt_pk_bf16_f32 v108, v108, v109
    v_cvt_pk_bf16_f32 v109, v110, v111
    s_cmp_eq_u32 s44, 7
    s_cselect_b64 exec, s[6:7], -1
    global_store_dwordx2 v63, v[108:109], s[34:35] offset:1024
    s_mov_b64 exec, -1
L_cdone:
    s_endpgm
L_rg:
    s_lshl_b32 s42, s41, 2
    s_lshl_b32 s43, s40, 8
    s_add_u32 s42, s42, s43
    s_lshl_b32 s43, s42, 2
    s_add_u32 s43, s43, 8192
    v_mov_b32 v49, s43
    s_sub_u32 s42, 2047, s42
    v_bfe_u32 v6, v3, 3, 1
    v_lshrrev_b32 v5, 5, v3
    v_lshl_add_u32 v5, v6, 1, v5
    s_lshl_b32 s43, s40, 4
    v_lshl_add_u32 v6, v5, 2, s43
    v_sub_u32 v5, s42, v5
    v_and_b32 v48, 15, v3
    v_lshlrev_b32 v48, 3, v48
    s_lshl_b32 s42, s41, 3
    s_add_u32 s42, s42, 4096
    v_mov_b32 v45, s42
    s_cmp_ge_u32 s41, 32
    s_cselect_b32 s43, 8, 0
    s_sub_u32 s42, s41, s43
    s_lshl_b32 s42, s42, 3
    s_add_u32 s42, s42, s40
    s_lshl_b32 s42, s42, 12
    v_and_b32 v47, 31, v3
    v_lshl_add_u32 v47, v47, 7, s42
    s_lshr_b32 s43, s42, 18
    s_lshl_b32 s43, s43, 9
    s_bfe_u32 s42, s42, 0x5000d
    s_mul_i32 s42, s42, 57344
    s_add_u32 s42, s42, s43
    v_and_b32 v39, 15, v3
    v_mul_u32_u24 v39, 3584, v39
    s_bitcmp1_b32 s40, 1
    s_cselect_b32 s43, 0, 0
    v_and_b32 v38, s43, v3
    v_xor_b32 v38, 48, v38
    v_lshl_add_u32 v39, v38, 3, v39
    v_add_u32 v39, s42, v39
    s_bitcmp1_b32 s40, 0
    s_cselect_b64 s[58:59], s[28:29], s[26:27]
    s_waitcnt lgkmcnt(0)
    s_add_u32 s48, s48, 2654435761
    v_mov_b32 v61, s48
    v_mov_b32 v41, s48
    v_mov_b32 v43, s48
    s_add_u32 s42, s41, s40
    s_cmp_lg_u32 s42, 0
    s_cbranch_scc1 L_anotag
    v_mov_b32 v7, 0
    v_mov_b32 v62, s48
    v_mov_b32 v63, 1
    s_mov_b64 exec, 1
    s_waitcnt vmcnt(0)
    global_store_dwordx2 v7, v[62:63], s[36:37] sc1
    s_mov_b64 exec, -1
    s_branch L_rg1
L_anotag:
    s_waitcnt vmcnt(2)
L_rg1:
    v_dot2_f32_bf16 v50, v16, v8, 0
    v_dot2_f32_bf16 v54, v16, v12, 0
    v_dot2_f32_bf16 v51, v20, v8, 0
    v_dot2_f32_bf16 v55, v20, v12, 0
    v_dot2_f32_bf16 v50, v17, v9, v50
    v_dot2_f32_bf16 v54, v17, v13, v54
    v_dot2_f32_bf16 v51, v21, v9, v51
    v_dot2_f32_bf16 v55, v21, v13, v55
    v_dot2_f32_bf16 v50, v18, v10, v50
    v_dot2_f32_bf16 v54, v18, v14, v54
    v_dot2_f32_bf16 v51, v22, v10, v51
    v_dot2_f32_bf16 v55, v22, v14, v55
    v_dot2_f32_bf16 v50, v19, v11, v50
    v_dot2_f32_bf16 v54, v19, v15, v54
    v_dot2_f32_bf16 v51, v23, v11, v51
    v_dot2_f32_bf16 v55, v23, v15, v55
    s_cbranch_scc0 L_rg2
    s_waitcnt vmcnt(0)
L_rg2:
    global_load_dword v38, v39, s[58:59]
    v_dot2_f32_bf16 v52, v24, v8, 0
    v_dot2_f32_bf16 v56, v24, v12, 0
    v_dot2_f32_bf16 v53, v28, v8, 0
    v_dot2_f32_bf16 v57, v28, v12, 0
    v_dot2_f32_bf16 v52, v25, v9, v52
    v_dot2_f32_bf16 v56, v25, v13, v56
    v_dot2_f32_bf16 v53, v29, v9, v53
    v_dot2_f32_bf16 v57, v29, v13, v57
    v_dot2_f32_bf16 v52, v26, v10, v52
    v_dot2_f32_bf16 v56, v26, v14, v56
    v_dot2_f32_bf16 v53, v30, v10, v53
    v_dot2_f32_bf16 v57, v30, v14, v57
    v_dot2_f32_bf16 v52, v27, v11, v52
    v_dot2_f32_bf16 v56, v27, v15, v56
    v_dot2_f32_bf16 v53, v31, v11, v53
    v_dot2_f32_bf16 v57, v31, v15, v57
    v_permlane32_swap_b32 v50, v51
    v_permlane32_swap_b32 v54, v55
    v_add_f32 v50, v50, v51
    v_permlane32_swap_b32 v52, v53
    v_add_f32 v54, v54, v55
    v_permlane32_swap_b32 v56, v57
    v_add_f32 v52, v52, v53
    v_add_f32 v56, v56, v57
    v_permlane16_swap_b32 v50, v54
    s_nop 0
    v_permlane16_swap_b32 v52, v56
    v_add_f32 v50, v50, v54
    v_add_f32 v52, v52, v56
    s_nop 0
    v_add_f32_dpp v51, v50, v50 row_ror:8 row_mask:0xf bank_mask:0x3
    v_add_f32_dpp v53, v52, v52 row_ror:8 row_mask:0xf bank_mask:0xf
    s_nop 1
    v_mov_b32_dpp v51, v53 quad_perm:[0,1,2,3] row_mask:0xf bank_mask:0xc
    s_nop 1
    v_add_f32_dpp v51, v51, v51 row_half_mirror row_mask:0xf bank_mask:0xf
    s_nop 1
    v_add_f32_dpp v51, v51, v51 quad_perm:[1,0,3,2] row_mask:0xf bank_mask:0xf
    s_nop 1
    v_add_f32_dpp v50, v51, v51 quad_perm:[2,3,0,1] row_mask:0xf bank_mask:0xf
    v_cvt_pk_bf16_f32 v50, 0, v50
    v_mul_f32 v52, 0xbfb8aa3b, v50
    v_exp_f32 v52, v52
    v_ashrrev_i32 v51, 31, v50
    v_add_f32 v52, 1.0, v52
    v_rcp_f32 v52, v52
    v_or_b32 v51, 0x80000000, v51
    v_xor_b32 v50, v50, v51
    v_mov_b32 v53, v52
    v_and_b32 v50, 0xffff0000, v50
    v_or_b32 v50, v50, v5
    v_permlane32_swap_b32 v52, v53
    s_mov_b32 exec_lo, 0x00000101
    s_mov_b32 exec_hi, 0x00000101
    ds_write_b32 v6, v50 offset:0
    s_mov_b64 exec, -1
    v_cvt_pk_bf16_f32 v40, v52, v53
    s_nop 1
    v_mov_b32_dpp v42, v40 row_ror:8 row_mask:0xf bank_mask:0xf
    s_mov_b64 exec, 0x10000
    global_store_dwordx4 v49, v[40:43], s[38:39] sc1
    s_mov_b64 exec, -1
    s_waitcnt lgkmcnt(0)
    s_barrier
    s_cmp_lg_u32 s40, 0
    s_cbranch_scc1 L_rg3
    ds_read_b64 v[52:53], v48 offset:0
    s_waitcnt lgkmcnt(0)
    v_max_u32 v60, v52, v53
    s_nop 1
    v_max_u32_dpp v60, v60, v60 row_ror:8 row_mask:0xf bank_mask:0xf
    s_nop 1
    v_max_u32_dpp v60, v60, v60 row_ror:4 row_mask:0xf bank_mask:0xf
    s_nop 1
    v_max_u32_dpp v60, v60, v60 row_ror:2 row_mask:0xf bank_mask:0xf
    s_nop 1
    v_max_u32_dpp v60, v60, v60 row_ror:1 row_mask:0xf bank_mask:0xf
    s_mov_b64 exec, 1
    global_store_dwordx2 v45, v[60:61], s[38:39] sc1
    s_mov_b64 exec, -1
L_rg3:
    s_lshr_b32 s42, s41, 3
    s_cmp_eq_u32 s42, 3
    s_cbranch_scc1 L_adone
    s_barrier
    global_load_dword v46, v47, s[30:31]
    s_waitcnt vmcnt(0)
    s_branch L_adone
L_ffn:
    s_cmp_eq_u32 s42, 3
    s_cbranch_scc1 L_adone
    s_lshr_b32 s62, s41, 1
    s_cmp_gt_u32 s42, 3
    s_cselect_b32 s43, 8, 0
    s_sub_u32 s62, s62, s43
    v_lshrrev_b32 v8, 2, v3
    v_and_b32 v9, 3, v3
    v_mul_u32_u24 v16, 3584, v8
    v_lshl_add_u32 v16, v9, 4, v16
    s_mul_i32 s42, s40, 229376
    s_lshl_b32 s43, s62, 6
    s_add_u32 s42, s42, s43
    s_mul_i32 s57, s40, 12288
    s_and_b32 s43, s62, 1
    s_mul_i32 s56, s43, 114688
    s_lshl_b32 s43, s43, 11
    s_add_u32 s58, s57, s43
    s_xor_b32 s59, s58, 2048
    s_add_u32 s43, s42, s56
    s_sub_u32 s42, s42, s56
    s_add_u32 s42, s42, 114688
    v_add_u32 v18, s42, v16
    v_add_u32 v16, s43, v16
    v_add_u32 v17, 57344, v16
    v_add_u32 v19, 57344, v18
    s_waitcnt lgkmcnt(0)
    s_add_u32 m0, s58, 0
    s_nop 0
    global_load_lds_dwordx4 v16, s[26:27]
    s_add_u32 m0, s58, 4096
    s_nop 0
    global_load_lds_dwordx4 v16, s[28:29]
    s_add_u32 m0, s58, 1024
    s_nop 0
    global_load_lds_dwordx4 v17, s[26:27]
    s_add_u32 m0, s58, 5120
    s_nop 0
    global_load_lds_dwordx4 v17, s[28:29]
    v_lshrrev_b32 v44, 3, v3
    v_and_b32 v21, 7, v3
    v_lshlrev_b32 v21, 4, v21
    v_lshl_add_u32 v44, v44, 10, v21
    s_lshl_b32 s42, s62, 15
    s_lshl_b32 s43, s40, 7
    s_add_u32 s42, s42, s43
    v_add_u32 v44, s42, v44
    v_lshlrev_b32 v22, 3, v3
    v_add_u32 v22, 4096, v22
    v_mov_b32 v23, 0
    s_barrier
    s_add_u32 m0, s59, 0
    s_nop 0
    global_load_lds_dwordx4 v18, s[26:27]
    s_add_u32 m0, s59, 4096
    s_nop 0
    global_load_lds_dwordx4 v18, s[28:29]
    s_add_u32 m0, s59, 1024
    s_nop 0
    global_load_lds_dwordx4 v19, s[26:27]
    s_add_u32 m0, s59, 5120
    s_nop 0
    global_load_lds_dwordx4 v19, s[28:29]
    v_and_b32 v5, 15, v3
    v_lshrrev_b32 v6, 4, v3
    v_bfe_u32 v14, v3, 2, 2
    v_lshlrev_b32 v14, 6, v14
    v_lshl_add_u32 v14, v6, 9, v14
    v_lshl_add_u32 v14, v9, 3, v14
    v_add_u32 v14, s57, v14
    v_lshlrev_b32 v8, 7, v8
    v_lshl_add_u32 v8, v9, 3, v8
    v_add_u32 v8, s57, v8
    s_lshl_b32 s43, s40, 7
    s_add_u32 s43, s43, 100416
    v_lshl_add_u32 v10, v6, 4, s43
    v_lshrrev_b32 v12, 2, v5
    v_lshlrev_b32 v13, 6, v12
    v_lshl_add_u32 v13, v6, 4, v13
    s_lshl_b32 s43, s40, 8
    s_add_u32 s43, s43, 98368
    v_lshl_add_u32 v11, v3, 2, s43
    v_lshl_add_u32 v13, v9, 2, v13
    v_add_u32 v7, 98368, v13
    v_lshl_add_u32 v13, v12, 2, v6
    s_lshl_b32 s43, s40, 8
    s_mul_i32 s56, s62, 2176
    s_add_u32 s43, s43, s56
    s_add_u32 s43, s43, 32768
    v_lshl_add_u32 v13, v3, 2, s43
    v_lshlrev_b32 v46, 3, v9
    v_mov_b32 v21, 98304
    s_waitcnt vmcnt(0)
    s_cmp_eq_u32 s40, 0
    s_cbranch_scc1 L_fnd
    s_add_u32 m0, s57, 8192
    s_nop 0
    global_load_lds_dwordx4 v44, s[30:31]
    s_add_u32 m0, m0, 1024
    v_add_u32 v44, 8192, v44
    global_load_lds_dwordx4 v44, s[30:31]
    s_add_u32 m0, m0, 1024
    v_add_u32 v44, 8192, v44
    global_load_lds_dwordx4 v44, s[30:31]
    s_add_u32 m0, m0, 1024
    v_add_u32 v44, 8192, v44
    global_load_lds_dwordx4 v44, s[30:31]
L_fnd:
    ds_read_b64_tr_b16 v[64:65], v14 offset:0
    ds_read_b64_tr_b16 v[80:81], v14 offset:4096
    ds_read_b64_tr_b16 v[66:67], v14 offset:256
    ds_read_b64_tr_b16 v[82:83], v14 offset:4352
    ds_read_b64_tr_b16 v[68:69], v14 offset:32
    ds_read_b64_tr_b16 v[84:85], v14 offset:4128
    ds_read_b64_tr_b16 v[70:71], v14 offset:288
    ds_read_b64_tr_b16 v[86:87], v14 offset:4384
    s_waitcnt lgkmcnt(4)
    ds_read_b64_tr_b16 v[72:73], v14 offset:2048
    ds_read_b64_tr_b16 v[88:89], v14 offset:6144
    ds_read_b64_tr_b16 v[74:75], v14 offset:2304
    ds_read_b64_tr_b16 v[90:91], v14 offset:6400
    ds_read_b64_tr_b16 v[76:77], v14 offset:2080
    ds_read_b64_tr_b16 v[92:93], v14 offset:6176
    ds_read_b64_tr_b16 v[78:79], v14 offset:2336
    ds_read_b64_tr_b16 v[94:95], v14 offset:6432
    s_waitcnt lgkmcnt(4)
    s_cmp_lg_u32 s40, 0
    s_cbranch_scc1 L_anopoll
    s_mov_b32 s51, 1048576
L_pk:
    global_load_dwordx2 v[16:17], v22, s[38:39] sc1
    global_load_dwordx2 v[18:19], v23, s[36:37] sc1
    s_waitcnt vmcnt(0)
L_pk1:
    v_cmp_eq_u32 vcc, v18, v17
    v_cmp_eq_u32 s[52:53], 1, v19
    s_and_b64 vcc, vcc, s[52:53]
    s_cmp_eq_u64 vcc, -1
    s_cbranch_scc1 L_pkd
    s_sub_u32 s51, s51, 1
    s_cbranch_scc0 L_pk
L_pkd:
    v_max_u32_dpp v16, v16, v16 row_ror:8 row_mask:0xf bank_mask:0xf
    s_nop 1
    v_max_u32_dpp v16, v16, v16 row_ror:4 row_mask:0xf bank_mask:0xf
    s_nop 1
    v_max_u32_dpp v16, v16, v16 row_ror:2 row_mask:0xf bank_mask:0xf
    s_nop 1
    v_max_u32_dpp v16, v16, v16 row_ror:1 row_mask:0xf bank_mask:0xf
    s_nop 1
    v_readlane_b32 s49, v16, 0
    v_readlane_b32 s42, v16, 16
    v_readlane_b32 s43, v16, 32
    v_readlane_b32 s56, v16, 48
    s_max_u32 s49, s49, s42
    s_max_u32 s43, s43, s56
    s_max_u32 s49, s49, s43
    s_andn2_b32 s50, 2047, s49
    s_lshl_b32 s42, s50, 10
    s_mov_b32 m0, 100416
    v_lshl_add_u32 v45, v3, 4, s42
    global_load_lds_dwordx4 v45, s[8:9]
    s_add_u32 m0, s57, 8192
    s_nop 0
    global_load_lds_dwordx4 v44, s[30:31]
    s_add_u32 m0, m0, 1024
    v_add_u32 v44, 8192, v44
    global_load_lds_dwordx4 v44, s[30:31]
    s_add_u32 m0, m0, 1024
    v_add_u32 v44, 8192, v44
    global_load_lds_dwordx4 v44, s[30:31]
    s_add_u32 m0, m0, 1024
    v_add_u32 v44, 8192, v44
    global_load_lds_dwordx4 v44, s[30:31]
    v_mov_b32 v16, s49
    ds_write_b64 v21, v[16:17]
    s_waitcnt vmcnt(4)
L_anopoll:
    s_waitcnt lgkmcnt(0)
    s_barrier
    ds_read_b128 v[16:19], v10
    ds_read_b128 v[40:43], v10 offset:64
    ds_read_b32 v128, v21 offset:4
    s_waitcnt lgkmcnt(1)
    v_mfma_f32_16x16x32_bf16 v[24:27], v[16:19], v[64:67], 0
    v_mfma_f32_16x16x32_bf16 v[24:27], v[40:43], v[72:75], v[24:27]
    v_mfma_f32_16x16x32_bf16 v[28:31], v[16:19], v[68:71], 0
    v_mfma_f32_16x16x32_bf16 v[28:31], v[40:43], v[76:79], v[28:31]
    v_mfma_f32_16x16x32_bf16 v[32:35], v[16:19], v[80:83], 0
    v_mfma_f32_16x16x32_bf16 v[32:35], v[40:43], v[88:91], v[32:35]
    v_mfma_f32_16x16x32_bf16 v[36:39], v[16:19], v[84:87], 0
    v_mfma_f32_16x16x32_bf16 v[36:39], v[40:43], v[92:95], v[36:39]
    s_waitcnt lgkmcnt(0)
    v_lshrrev_b32 v129, v46, v128
    s_nop 1
    v_mov_b32_dpp v24, v28 quad_perm:[0,1,2,3] row_mask:0x2 bank_mask:0xf
    s_nop 1
    v_mov_b32_dpp v24, v32 quad_perm:[0,1,2,3] row_mask:0x4 bank_mask:0xf
    s_nop 1
    v_mov_b32_dpp v24, v36 quad_perm:[0,1,2,3] row_mask:0x8 bank_mask:0xf
    ds_write_b32 v11, v24
    s_waitcnt lgkmcnt(0)
    s_barrier
    ds_read2st64_b32 v[16:17], v7 offset0:0 offset1:1
    ds_read2st64_b32 v[18:19], v7 offset0:2 offset1:3
    ds_read2st64_b32 v[20:21], v7 offset0:4 offset1:5
    ds_read2st64_b32 v[22:23], v7 offset0:6 offset1:7
    s_mov_b32 s42, 0xff
    s_waitcnt lgkmcnt(2)
    v_pk_add_f32 v[16:17], v[16:17], v[18:19]
    s_waitcnt lgkmcnt(0)
    v_pk_add_f32 v[20:21], v[20:21], v[22:23]
    v_pk_add_f32 v[16:17], v[16:17], v[20:21]
    v_add_f32 v16, v16, v17
    s_waitcnt vmcnt(0)
    ds_read_b64_tr_b16 v[96:97], v8 offset:8192
    ds_read_b64_tr_b16 v[98:99], v8 offset:10240
    ds_read_b64_tr_b16 v[100:101], v8 offset:8224
    ds_read_b64_tr_b16 v[102:103], v8 offset:10272
    ds_read_b64_tr_b16 v[104:105], v8 offset:8256
    ds_read_b64_tr_b16 v[106:107], v8 offset:10304
    ds_read_b64_tr_b16 v[108:109], v8 offset:8288
    ds_read_b64_tr_b16 v[110:111], v8 offset:10336
    v_cvt_pk_bf16_f32 v18, 0, v16
    v_mul_f32 v16, 0xbfb8aa3b, v18
    v_exp_f32 v16, v16
    v_mov_b32_dpp v19, v18 row_ror:8 row_mask:0xf bank_mask:0xf
    v_add_f32 v16, 1.0, v16
    v_rcp_f32 v16, v16
    s_nop 0
    v_mul_f32 v16, v16, v18
    v_cvt_pk_bf16_f32 v16, 0, v16
    v_mul_f32 v16, v16, v19
    s_nop 1
    v_mov_b32_dpp v17, v16 quad_perm:[1,1,3,3] row_mask:0xf bank_mask:0xf
    v_cvt_pk_bf16_f32 v16, v16, v17
    s_nop 1
    v_mov_b32_dpp v112, v16 row_newbcast:0 row_mask:0xf bank_mask:0xf
    v_mov_b32_dpp v113, v16 row_newbcast:2 row_mask:0xf bank_mask:0xf
    v_mov_b32_dpp v114, v16 row_newbcast:4 row_mask:0xf bank_mask:0xf
    v_mov_b32_dpp v115, v16 row_newbcast:6 row_mask:0xf bank_mask:0xf
    s_waitcnt lgkmcnt(0)
    s_nop 0
    v_mfma_f32_16x16x32_bf16 v[24:27], v[112:115], v[96:99], 0
    v_mfma_f32_16x16x32_bf16 v[28:31], v[112:115], v[100:103], 0
    v_mfma_f32_16x16x32_bf16 v[32:35], v[112:115], v[104:107], 0
    v_mfma_f32_16x16x32_bf16 v[36:39], v[112:115], v[108:111], 0
    s_nop 6
    v_mov_b32_dpp v24, v28 quad_perm:[0,1,2,3] row_mask:0x2 bank_mask:0xf
    v_mov_b32_dpp v36, v32 quad_perm:[0,1,2,3] row_mask:0x4 bank_mask:0xf
    s_nop 1
    v_mov_b32_dpp v24, v36 quad_perm:[0,1,2,3] row_mask:0xc bank_mask:0xf
    v_bfi_b32 v24, s42, v129, v24
    global_store_dword v13, v24, s[38:39] sc1
    s_add_u32 s42, s62, s40
    s_cmp_lg_u32 s42, 0
    s_cbranch_scc1 L_adone
    s_mov_b64 exec, 1
    v_mov_b32 v23, 0
    global_store_dword v23, v128, s[38:39] offset:0 sc1
L_adone:
L_end:
    s_endpgm
.section .rodata,"a"
.p2align 6
.amdhsa_kernel gated_mix__ssm_conv_s4d__moe_arch_mod__prompt_kernel
  .amdhsa_next_free_vgpr 256
  .amdhsa_next_free_sgpr 96
  .amdhsa_accum_offset 256
  .amdhsa_group_segment_fixed_size 0
  .amdhsa_kernarg_size 128
  .amdhsa_user_sgpr_count 2
  .amdhsa_user_sgpr_kernarg_segment_ptr 1
  .amdhsa_system_sgpr_workgroup_id_x 1
.end_amdhsa_kernel
```
